```python
import torch

def _softmax(x, axis=-1):
    return torch.softmax(x, dim=axis)
def _gelu(x):
    return torch.nn.functional.gelu(x, approximate="tanh")
def _silu(x):
    return torch.nn.functional.silu(x)
def _sigmoid(x):
    return torch.sigmoid(x)
def _layernorm(x, axis=-1, eps=1e-5):
    m = x.mean(dim=axis, keepdim=True)
    v = x.var(dim=axis, keepdim=True, unbiased=False)
    return (x - m) / torch.sqrt(v + eps)
def _scatter_add(tgt, idx, src, axis=0):
    return tgt.clone().index_add_(axis, idx, src)
def _segment_sum(src, seg, n):
    out = torch.zeros((n,) + src.shape[1:], dtype=src.dtype)
    return out.index_add_(0, seg, src)
def _pad(x, pw):
    flat = tuple(v for pair in reversed(pw) for v in pair)
    return torch.nn.functional.pad(x, flat)

kernel_name = 'standalone__paged_block_table_kv_pagedattention__sampling'

def setup_inputs():

    _w = (lambda a: (lambda t: t.to(torch.bfloat16) if t.is_floating_point() else t)(torch.as_tensor(a)))
    B, Hq, Hkv, Sq, Skv, D = 16, 16, 8, 16, 2048, 256
    bs = 16
    nbps = max(1, Skv // bs)
    num_phys = B * nbps + 4
    bt = torch.randperm(num_phys)[: B * nbps].reshape(B, nbps).to(torch.int64)
    cl = (nbps * bs - (torch.arange(1, B + 1, dtype=torch.int64) * 2654435761) % max(1, nbps * bs // 2)).to(torch.int64)
    return {
        "q": _w((lambda *s: torch.randn(*s, dtype=torch.bfloat16) * 0.8)(B, Hq, Sq, D)),
        "k_cache": _w((lambda *s: torch.randn(*s, dtype=torch.bfloat16) * 0.8)(num_phys, bs, Hkv, D)),
        "v_cache": _w((lambda *s: torch.randn(*s, dtype=torch.bfloat16) * 0.05)(num_phys, bs, Hkv, D)),
        "block_table": _w(bt),
        "context_lens": _w(cl),
    }

def reference(q, k_cache, v_cache, block_table, context_lens):
    B, Hq, Sq, D = q.shape
    bs = k_cache.shape[1]
    Hkv = k_cache.shape[2]
    nbps = block_table.shape[1]
    Skv = nbps * bs
    bt = block_table.reshape(-1)
    k = (lambda x, *d: x.permute(*d))(k_cache[bt].reshape(B, Skv, Hkv, D), 0, 2, 1, 3)
    v = (lambda x, *d: x.permute(*d))(v_cache[bt].reshape(B, Skv, Hkv, D), 0, 2, 1, 3)
    g = Hq // Hkv
    qg = q.reshape(B, Hkv, g, Sq, D)
    scores = torch.einsum("bhgqd,bhkd->bhgqk", qg, k) * (D ** -0.5)
    pos = torch.arange(Skv)
    msk = pos[None, :] < context_lens[:, None]
    scores = torch.where(msk[:, None, None, None, :], scores, -1e9)
    p = _softmax(scores, axis=-1)
    out = torch.einsum("bhgqk,bhkd->bhgqd", p, v)
    return out.reshape(B, Hq, Sq, D)
```

```asm
; @launch grid=(256,1,1) block=(512,1,1) lds=131136
.amdgcn_target "amdgcn-amd-amdhsa--gfx950"
.text
.globl standalone__paged_block_table_kv_pagedattention__sampling_kernel
.p2align 8
.type standalone__paged_block_table_kv_pagedattention__sampling_kernel,@function
standalone__paged_block_table_kv_pagedattention__sampling_kernel:
    s_cmp_ge_u32 s2, 256
    s_cbranch_scc1 L_end
    s_load_dwordx16 s[8:23], s[0:1], 0
    v_lshrrev_b32 v2, 6, v0
    v_and_b32 v1, 63, v0
    v_readfirstlane_b32 s52, v2
    s_and_b32 s4, s2, 7
    s_lshr_b32 s5, s2, 3
    s_and_b32 s3, s52, 3
    s_cmp_lt_u32 s52, 4
    s_cbranch_scc1 L_consumer
    s_and_b32 s52, s3, 1
    s_lshl_b32 s53, s52, 3
    v_lshrrev_b32 v4, 5, v1
    v_add_u32 v4, s53, v4
    v_and_b32 v5, 31, v1
    s_lshr_b32 s54, s3, 1
    s_lshl_b32 s55, s54, 13
    v_lshlrev_b32 v38, 1, v1
    v_add_u32 v38, s54, v38
    v_add_u32 v6, 0, v4
    v_lshrrev_b32 v8, 5, v1
    s_lshl_b32 s53, s52, 2
    v_lshl_add_u32 v8, v8, 3, s53
    v_add_u32 v7, 0, v8
    v_xor_b32 v20, v5, v6
    v_lshlrev_b32 v20, 4, v20
    v_lshl_add_u32 v28, v6, 9, v20
    v_lshl_add_u32 v20, v7, 12, v20
    v_and_b32 v24, 7, v6
    v_lshlrev_b32 v24, 1, v24
    v_xor_b32 v24, v5, v24
    v_lshlrev_b32 v24, 4, v24
    v_lshl_add_u32 v24, v7, 12, v24
    v_add_u32 v28, s55, v28
    v_add_u32 v6, 2, v4
    v_add_u32 v7, 1, v8
    v_xor_b32 v21, v5, v6
    v_lshlrev_b32 v21, 4, v21
    v_lshl_add_u32 v29, v6, 9, v21
    v_lshl_add_u32 v21, v7, 12, v21
    v_and_b32 v25, 7, v6
    v_lshlrev_b32 v25, 1, v25
    v_xor_b32 v25, v5, v25
    v_lshlrev_b32 v25, 4, v25
    v_lshl_add_u32 v25, v7, 12, v25
    v_add_u32 v29, s55, v29
    v_subrev_u32 v21, 1024, v21
    v_subrev_u32 v25, 1024, v25
    v_subrev_u32 v29, 1024, v29
    v_add_u32 v6, 4, v4
    v_add_u32 v7, 2, v8
    v_xor_b32 v22, v5, v6
    v_lshlrev_b32 v22, 4, v22
    v_lshl_add_u32 v30, v6, 9, v22
    v_lshl_add_u32 v22, v7, 12, v22
    v_and_b32 v26, 7, v6
    v_lshlrev_b32 v26, 1, v26
    v_xor_b32 v26, v5, v26
    v_lshlrev_b32 v26, 4, v26
    v_lshl_add_u32 v26, v7, 12, v26
    v_add_u32 v30, s55, v30
    v_subrev_u32 v22, 2048, v22
    v_subrev_u32 v26, 2048, v26
    v_subrev_u32 v30, 2048, v30
    v_add_u32 v6, 6, v4
    v_add_u32 v7, 3, v8
    v_xor_b32 v23, v5, v6
    v_lshlrev_b32 v23, 4, v23
    v_lshl_add_u32 v31, v6, 9, v23
    v_lshl_add_u32 v23, v7, 12, v23
    v_and_b32 v27, 7, v6
    v_lshlrev_b32 v27, 1, v27
    v_xor_b32 v27, v5, v27
    v_lshlrev_b32 v27, 4, v27
    v_lshl_add_u32 v27, v7, 12, v27
    v_add_u32 v31, s55, v31
    v_subrev_u32 v23, 3072, v23
    v_subrev_u32 v27, 3072, v27
    v_subrev_u32 v31, 3072, v31
    s_lshl_b32 s72, s3, 12
    v_lshlrev_b32 v3, 2, v1
    s_waitcnt lgkmcnt(0)
    s_mov_b32 s24, s16
    s_mov_b32 s25, s17
    s_mov_b32 s26, 0x40
    s_mov_b32 s27, 0x20000
    buffer_load_dword v33, v3, s[24:27], 0 offen
    s_mov_b32 s48, s14
    s_mov_b32 s49, s15
    s_mov_b32 s50, 0x2000
    s_mov_b32 s51, 0x20000
    s_mov_b32 s40, s8
    s_mov_b32 s41, s9
    s_mov_b32 s42, 0x200000
    s_mov_b32 s43, 0x20000
    s_mov_b32 s44, s8
    s_mov_b32 s45, s9
    s_mov_b32 s46, 0x0
    s_mov_b32 s47, 0x20000
    s_cmp_ge_u32 s5, 16
    s_cbranch_scc1 L_pC_1
    v_add_u32 v4, -2, v38
    v_max_i32 v4, 0, v4
    s_lshl_b32 s52, s5, 9
    v_lshl_add_u32 v4, v4, 2, s52
    buffer_load_dword v32, v4, s[48:51], 0 offen
    s_lshl_b32 s52, s5, 3
    s_add_u32 s52, s52, s4
    s_lshl_b32 s71, s52, 14
    s_mov_b32 m0, s72
    s_nop 0
    buffer_load_dwordx4 v28, s[40:43], s71 offen offset:0 lds
    buffer_load_dwordx4 v29, s[40:43], s71 offen offset:1024 lds
    buffer_load_dwordx4 v30, s[40:43], s71 offen offset:2048 lds
    buffer_load_dwordx4 v31, s[40:43], s71 offen offset:3072 lds
    s_add_u32 m0, m0, 16384
    s_nop 0
    buffer_load_dwordx4 v28, s[44:47], s71 offen offset:0 lds
    buffer_load_dwordx4 v29, s[44:47], s71 offen offset:1024 lds
    buffer_load_dwordx4 v30, s[44:47], s71 offen offset:2048 lds
    buffer_load_dwordx4 v31, s[44:47], s71 offen offset:3072 lds
    s_mov_b32 s32, s10
    s_mov_b32 s33, s11
    s_mov_b32 s34, 0x8040000
    s_mov_b32 s35, 0x20000
    s_mov_b32 s36, s12
    s_mov_b32 s37, s13
    s_mov_b32 s38, 0x8040000
    s_mov_b32 s39, 0x20000
    s_lshl_b32 s53, s4, 9
    s_waitcnt vmcnt(8)
    v_readlane_b32 s52, v33, s5
    v_lshl_add_u32 v32, v32, 16, s53
    s_max_i32 s52, s52, 0
    s_sub_u32 s52, s52, 1
    s_min_u32 s52, s52, 0x7ff
    s_lshr_b32 s52, s52, 5
    v_readlane_b32 s71, v32, 1
    s_add_u32 m0, s72, 32768
    s_nop 3
    buffer_load_dwordx4 v20, s[32:35], s71 offen offset:0 nt lds
    buffer_load_dwordx4 v21, s[32:35], s71 offen offset:1024 nt lds
    buffer_load_dwordx4 v22, s[32:35], s71 offen offset:2048 nt lds
    buffer_load_dwordx4 v23, s[32:35], s71 offen offset:3072 nt lds
    s_add_u32 m0, m0, 16384
    s_nop 0
    buffer_load_dwordx4 v24, s[36:39], s71 offen offset:0 nt lds
    buffer_load_dwordx4 v25, s[36:39], s71 offen offset:1024 nt lds
    buffer_load_dwordx4 v26, s[36:39], s71 offen offset:2048 nt lds
    buffer_load_dwordx4 v27, s[36:39], s71 offen offset:3072 nt lds
    s_cmp_lt_u32 s52, 1
    s_cbranch_scc1 L_fpd_3
    v_readlane_b32 s71, v32, 2
    s_add_u32 m0, s72, 65536
    s_nop 3
    buffer_load_dwordx4 v20, s[32:35], s71 offen offset:0 nt lds
    buffer_load_dwordx4 v21, s[32:35], s71 offen offset:1024 nt lds
    buffer_load_dwordx4 v22, s[32:35], s71 offen offset:2048 nt lds
    buffer_load_dwordx4 v23, s[32:35], s71 offen offset:3072 nt lds
    s_add_u32 m0, m0, 16384
    s_nop 0
    buffer_load_dwordx4 v24, s[36:39], s71 offen offset:0 nt lds
    buffer_load_dwordx4 v25, s[36:39], s71 offen offset:1024 nt lds
    buffer_load_dwordx4 v26, s[36:39], s71 offen offset:2048 nt lds
    buffer_load_dwordx4 v27, s[36:39], s71 offen offset:3072 nt lds
L_fpd_3:
    v_max_i32 v33, 0, v33
    v_add_u32 v34, -1, v33
    v_min_u32 v34, 0x7ff, v34
    v_lshrrev_b32 v34, 5, v34
    v_add_u32 v34, 1, v34
    v_mov_b32 v35, v34
    s_nop 1
    v_add_u32_dpp v35, v35, v35 row_shr:1 row_mask:0xf bank_mask:0xf bound_ctrl:1
    s_nop 1
    v_add_u32_dpp v35, v35, v35 row_shr:2 row_mask:0xf bank_mask:0xf bound_ctrl:1
    s_nop 1
    v_add_u32_dpp v35, v35, v35 row_shr:4 row_mask:0xf bank_mask:0xf bound_ctrl:1
    s_nop 1
    v_add_u32_dpp v35, v35, v35 row_shr:8 row_mask:0xf bank_mask:0xf bound_ctrl:1
    s_nop 0
    v_readlane_b32 s52, v35, 15
    s_mov_b32 s66, 0xffff
    s_add_u32 s52, s52, 95
    s_lshr_b32 s57, s52, 5
L_refine_4:
    v_cmp_le_u32 vcc, s57, v34
    s_and_b32 s52, vcc_lo, s66
    s_cmp_eq_u32 s52, s66
    s_cbranch_scc1 L_refdone_5
    s_mov_b32 s66, s52
    s_bcnt1_i32_b32 s53, s66
    s_mov_b32 vcc_lo, s66
    s_add_u32 s53, s53, 16
    v_cndmask_b32 v35, 0, v34, vcc
    v_cvt_f32_u32 v2, s53
    s_nop 0
    v_add_u32_dpp v35, v35, v35 row_shr:1 row_mask:0xf bank_mask:0xf bound_ctrl:1
    s_nop 1
    v_add_u32_dpp v35, v35, v35 row_shr:2 row_mask:0xf bank_mask:0xf bound_ctrl:1
    s_nop 1
    v_add_u32_dpp v35, v35, v35 row_shr:4 row_mask:0xf bank_mask:0xf bound_ctrl:1
    s_nop 1
    v_add_u32_dpp v35, v35, v35 row_shr:8 row_mask:0xf bank_mask:0xf bound_ctrl:1
    v_rcp_f32 v2, v2
    v_readlane_b32 s52, v35, 15
    s_lshl1_add_u32 s52, s53, s52
    s_add_u32 s52, s52, 31
    v_cvt_f32_u32 v3, s52
    v_add_f32 v3, 0.5, v3
    v_mul_f32 v3, v3, v2
    v_cvt_u32_f32 v3, v3
    s_nop 0
    v_readfirstlane_b32 s52, v3
    s_max_u32 s57, s57, s52
    s_branch L_refine_4
L_refdone_5:
    s_max_u32 s57, s57, 3
    s_min_u32 s57, s57, 63
    v_subrev_u32 v36, s57, v34
    v_cmp_lt_u32 vcc, s57, v34
    v_add_u32 v36, 1, v36
    s_nop 0
    v_cndmask_b32 v36, 0, v36, vcc
    v_mov_b32 v35, v36
    s_nop 1
    v_add_u32_dpp v35, v35, v35 row_shr:1 row_mask:0xf bank_mask:0xf bound_ctrl:1
    s_nop 1
    v_add_u32_dpp v35, v35, v35 row_shr:2 row_mask:0xf bank_mask:0xf bound_ctrl:1
    s_nop 1
    v_add_u32_dpp v35, v35, v35 row_shr:4 row_mask:0xf bank_mask:0xf bound_ctrl:1
    s_nop 1
    v_add_u32_dpp v35, v35, v35 row_shr:8 row_mask:0xf bank_mask:0xf bound_ctrl:1
    s_nop 0
    v_readlane_b32 s58, v35, 15
    v_readlane_b32 s64, v34, s5
    v_readlane_b32 s52, v35, s5
    v_readlane_b32 s53, v36, s5
    v_mul_u32_u24 v2, s58, v1
    s_min_u32 s7, s64, s57
    v_add_u32 v3, s58, v2
    s_add_u32 s7, s7, 1
    v_lshrrev_b32 v2, 4, v2
    s_sub_u32 s53, s52, s53
    s_add_u32 s53, s53, 1
    v_lshrrev_b32 v3, 4, v3
    v_max_u32 v2, s53, v2
    v_min_u32 v3, s52, v3
    v_cmp_lt_u32 vcc, v2, v3
    s_mov_b64 s[68:69], 1
    s_and_b32 s62, vcc_lo, 0xffff
    s_bcnt1_i32_b32 s63, s62
    s_mov_b32 s28, s20
    s_mov_b32 s29, s21
    s_mov_b32 s30, 0x100
    s_mov_b32 s31, 0x20000
    s_lshl_b32 s52, s4, 4
    s_add_u32 s52, s52, s5
    s_and_b32 s73, s52, 0x7c
    s_branch L_ploop0_2
L_pC_1:
    s_mov_b32 s32, s10
    s_mov_b32 s33, s11
    s_mov_b32 s34, 0x8040000
    s_mov_b32 s35, 0x20000
    s_mov_b32 s36, s12
    s_mov_b32 s37, s13
    s_mov_b32 s38, 0x8040000
    s_mov_b32 s39, 0x20000
    s_waitcnt vmcnt(0)
    v_max_i32 v33, 0, v33
    v_add_u32 v34, -1, v33
    v_min_u32 v34, 0x7ff, v34
    v_lshrrev_b32 v34, 5, v34
    v_add_u32 v34, 1, v34
    v_mov_b32 v35, v34
    s_nop 1
    v_add_u32_dpp v35, v35, v35 row_shr:1 row_mask:0xf bank_mask:0xf bound_ctrl:1
    s_nop 1
    v_add_u32_dpp v35, v35, v35 row_shr:2 row_mask:0xf bank_mask:0xf bound_ctrl:1
    s_nop 1
    v_add_u32_dpp v35, v35, v35 row_shr:4 row_mask:0xf bank_mask:0xf bound_ctrl:1
    s_nop 1
    v_add_u32_dpp v35, v35, v35 row_shr:8 row_mask:0xf bank_mask:0xf bound_ctrl:1
    s_nop 0
    v_readlane_b32 s52, v35, 15
    s_mov_b32 s66, 0xffff
    s_add_u32 s52, s52, 95
    s_lshr_b32 s57, s52, 5
L_refine_6:
    v_cmp_le_u32 vcc, s57, v34
    s_and_b32 s52, vcc_lo, s66
    s_cmp_eq_u32 s52, s66
    s_cbranch_scc1 L_refdone_7
    s_mov_b32 s66, s52
    s_bcnt1_i32_b32 s53, s66
    s_mov_b32 vcc_lo, s66
    s_add_u32 s53, s53, 16
    v_cndmask_b32 v35, 0, v34, vcc
    v_cvt_f32_u32 v2, s53
    s_nop 0
    v_add_u32_dpp v35, v35, v35 row_shr:1 row_mask:0xf bank_mask:0xf bound_ctrl:1
    s_nop 1
    v_add_u32_dpp v35, v35, v35 row_shr:2 row_mask:0xf bank_mask:0xf bound_ctrl:1
    s_nop 1
    v_add_u32_dpp v35, v35, v35 row_shr:4 row_mask:0xf bank_mask:0xf bound_ctrl:1
    s_nop 1
    v_add_u32_dpp v35, v35, v35 row_shr:8 row_mask:0xf bank_mask:0xf bound_ctrl:1
    v_rcp_f32 v2, v2
    v_readlane_b32 s52, v35, 15
    s_lshl1_add_u32 s52, s53, s52
    s_add_u32 s52, s52, 31
    v_cvt_f32_u32 v3, s52
    v_add_f32 v3, 0.5, v3
    v_mul_f32 v3, v3, v2
    v_cvt_u32_f32 v3, v3
    s_nop 0
    v_readfirstlane_b32 s52, v3
    s_max_u32 s57, s57, s52
    s_branch L_refine_6
L_refdone_7:
    s_max_u32 s57, s57, 3
    s_min_u32 s57, s57, 63
    v_subrev_u32 v36, s57, v34
    v_cmp_lt_u32 vcc, s57, v34
    v_add_u32 v36, 1, v36
    s_nop 0
    v_cndmask_b32 v36, 0, v36, vcc
    v_mov_b32 v35, v36
    s_nop 1
    v_add_u32_dpp v35, v35, v35 row_shr:1 row_mask:0xf bank_mask:0xf bound_ctrl:1
    s_nop 1
    v_add_u32_dpp v35, v35, v35 row_shr:2 row_mask:0xf bank_mask:0xf bound_ctrl:1
    s_nop 1
    v_add_u32_dpp v35, v35, v35 row_shr:4 row_mask:0xf bank_mask:0xf bound_ctrl:1
    s_nop 1
    v_add_u32_dpp v35, v35, v35 row_shr:8 row_mask:0xf bank_mask:0xf bound_ctrl:1
    s_nop 0
    v_readlane_b32 s58, v35, 15
    s_sub_u32 s52, s5, 16
    s_mul_i32 s59, s52, s58
    s_add_u32 s60, s59, s58
    s_lshr_b32 s59, s59, 4
    s_lshr_b32 s60, s60, 4
    s_cmp_eq_u32 s59, s60
    s_cbranch_scc1 L_end
    v_cmp_ge_u32 vcc, s59, v35
    s_mov_b32 s65, 0
    s_mov_b64 s[68:69], 0
    s_mov_b32 s62, 0
    s_mov_b32 s63, 0
    s_and_b32 s52, vcc_lo, 0xffff
    s_bcnt1_i32_b32 s61, s52
L_seg_8:
    v_readlane_b32 s52, v36, s61
    v_readlane_b32 s53, v35, s61
    v_readlane_b32 s54, v33, s61
    v_cmp_le_u32 vcc, s65, v1
    s_sub_u32 s52, s53, s52
    s_add_u32 s52, s52, 1
    s_max_u32 s55, s52, s59
    s_min_u32 s56, s53, s60
    s_cmp_ge_u32 s55, s56
    s_cbranch_scc1 L_segnext_9
    s_sub_u32 s52, s55, s52
    s_add_u32 s52, s52, s57
    s_sub_u32 s52, s52, s65
    s_sub_u32 s52, s52, 1
    v_mov_b32 v2, s61
    v_mov_b32 v3, s52
    v_mov_b32 v4, s54
    v_cndmask_b32 v10, v10, v2, vcc
    v_cndmask_b32 v11, v11, v3, vcc
    v_cndmask_b32 v12, v12, v4, vcc
    s_bitset1_b64 s[68:69], s65
    s_sub_u32 s56, s56, s55
    s_add_u32 s65, s65, s56
    s_add_u32 s65, s65, 1
L_segnext_9:
    s_add_u32 s61, s61, 1
    s_cmp_lt_u32 s53, s60
    s_cbranch_scc1 L_seg_8
    s_mov_b32 s7, s65
    s_cmp_eq_u32 s65, 0
    s_cbranch_scc1 L_end
    v_add_u32 v11, v11, v1
    v_add_u32 v5, -1, v12
    v_min_u32 v5, 0x7ff, v5
    s_lshr_b32 s52, s3, 1
    v_lshl_add_u32 v4, v11, 1, s52
    v_lshrrev_b32 v5, 4, v5
    v_min_u32 v4, v4, v5
    v_lshl_add_u32 v4, v10, 7, v4
    v_lshlrev_b32 v4, 2, v4
    buffer_load_dword v32, v4, s[48:51], 0 offen
    v_lshl_add_u32 v5, v10, 3, s4
    v_lshlrev_b32 v5, 14, v5
    s_nop 0
    v_readfirstlane_b32 s71, v5
    s_mov_b32 m0, s72
    s_nop 3
    buffer_load_dwordx4 v28, s[40:43], s71 offen offset:0 lds
    buffer_load_dwordx4 v29, s[40:43], s71 offen offset:1024 lds
    buffer_load_dwordx4 v30, s[40:43], s71 offen offset:2048 lds
    buffer_load_dwordx4 v31, s[40:43], s71 offen offset:3072 lds
    s_add_u32 m0, m0, 16384
    s_nop 0
    buffer_load_dwordx4 v28, s[44:47], s71 offen offset:0 lds
    buffer_load_dwordx4 v29, s[44:47], s71 offen offset:1024 lds
    buffer_load_dwordx4 v30, s[44:47], s71 offen offset:2048 lds
    buffer_load_dwordx4 v31, s[44:47], s71 offen offset:3072 lds
    s_lshl_b32 s53, s4, 9
    s_waitcnt vmcnt(8)
    v_lshl_add_u32 v32, v32, 16, s53
    v_cndmask_b32 v32, v32, v5, s[68:69]
    s_nop 0
    v_readlane_b32 s71, v32, 1
    s_bitcmp1_b64 s[68:69], 1
    s_cbranch_scc1 L_dq_10
    s_add_u32 m0, s72, 32768
    s_nop 1
    buffer_load_dwordx4 v20, s[32:35], s71 offen offset:0 nt lds
    buffer_load_dwordx4 v21, s[32:35], s71 offen offset:1024 nt lds
    buffer_load_dwordx4 v22, s[32:35], s71 offen offset:2048 nt lds
    buffer_load_dwordx4 v23, s[32:35], s71 offen offset:3072 nt lds
    s_add_u32 m0, m0, 16384
    s_nop 0
    buffer_load_dwordx4 v24, s[36:39], s71 offen offset:0 nt lds
    buffer_load_dwordx4 v25, s[36:39], s71 offen offset:1024 nt lds
    buffer_load_dwordx4 v26, s[36:39], s71 offen offset:2048 nt lds
    buffer_load_dwordx4 v27, s[36:39], s71 offen offset:3072 nt lds
    s_branch L_de_11
L_dq_10:
    s_add_u32 m0, s72, 32768
    s_nop 1
    buffer_load_dwordx4 v28, s[40:43], s71 offen offset:0 lds
    buffer_load_dwordx4 v29, s[40:43], s71 offen offset:1024 lds
    buffer_load_dwordx4 v30, s[40:43], s71 offen offset:2048 lds
    buffer_load_dwordx4 v31, s[40:43], s71 offen offset:3072 lds
    s_add_u32 m0, m0, 16384
    s_nop 0
    buffer_load_dwordx4 v28, s[44:47], s71 offen offset:0 lds
    buffer_load_dwordx4 v29, s[44:47], s71 offen offset:1024 lds
    buffer_load_dwordx4 v30, s[44:47], s71 offen offset:2048 lds
    buffer_load_dwordx4 v31, s[44:47], s71 offen offset:3072 lds
L_de_11:
    s_cmp_le_u32 s7, 2
    s_cbranch_scc1 L_ploop0_2
    v_readlane_b32 s71, v32, 2
    s_bitcmp1_b64 s[68:69], 2
    s_cbranch_scc1 L_dq_14
    s_add_u32 m0, s72, 65536
    s_nop 1
    buffer_load_dwordx4 v20, s[32:35], s71 offen offset:0 nt lds
    buffer_load_dwordx4 v21, s[32:35], s71 offen offset:1024 nt lds
    buffer_load_dwordx4 v22, s[32:35], s71 offen offset:2048 nt lds
    buffer_load_dwordx4 v23, s[32:35], s71 offen offset:3072 nt lds
    s_add_u32 m0, m0, 16384
    s_nop 0
    buffer_load_dwordx4 v24, s[36:39], s71 offen offset:0 nt lds
    buffer_load_dwordx4 v25, s[36:39], s71 offen offset:1024 nt lds
    buffer_load_dwordx4 v26, s[36:39], s71 offen offset:2048 nt lds
    buffer_load_dwordx4 v27, s[36:39], s71 offen offset:3072 nt lds
    s_branch L_de_15
L_dq_14:
    s_add_u32 m0, s72, 65536
    s_nop 1
    buffer_load_dwordx4 v28, s[40:43], s71 offen offset:0 lds
    buffer_load_dwordx4 v29, s[40:43], s71 offen offset:1024 lds
    buffer_load_dwordx4 v30, s[40:43], s71 offen offset:2048 lds
    buffer_load_dwordx4 v31, s[40:43], s71 offen offset:3072 lds
    s_add_u32 m0, m0, 16384
    s_nop 0
    buffer_load_dwordx4 v28, s[44:47], s71 offen offset:0 lds
    buffer_load_dwordx4 v29, s[44:47], s71 offen offset:1024 lds
    buffer_load_dwordx4 v30, s[44:47], s71 offen offset:2048 lds
    buffer_load_dwordx4 v31, s[44:47], s71 offen offset:3072 lds
L_de_15:
L_ploop0_2:
    s_mov_b32 s75, s7
    s_mov_b32 s6, 0
    v_mov_b32 v15, 131084
    v_mov_b32 v14, 1
    s_add_u32 s70, s72, 98304
    s_cmp_eq_u32 s3, 0
    s_cselect_b32 s66, s63, 0
    s_bitcmp1_b32 s4, 0
    s_cselect_b32 s78, 3, 0
    s_cselect_b32 s74, 5, 5
    s_sub_i32 s74, s7, s74
    s_max_i32 s74, s74, 0
    s_cmp_ge_u32 s5, 16
    s_cselect_b32 s74, 64, s74
L_ploop_18:
    s_sub_u32 s52, s75, s6
    s_cmp_ge_u32 s52, 3
    s_cbranch_scc1 L_w2_21
    s_cmp_eq_u32 s52, 2
    s_cbranch_scc1 L_w1_20
    s_waitcnt vmcnt(0)
    s_branch L_chk_22
L_w2_21:
    s_waitcnt vmcnt(16)
    s_branch L_go_19
L_w1_20:
    s_waitcnt vmcnt(8)
    s_branch L_go_19
L_chk_22:
    s_cmp_eq_u32 s66, 0
    s_cbranch_scc1 L_go_19
    v_readfirstlane_b32 s53, v37
    s_and_b32 s54, s5, 3
    s_lshl_b32 s54, s54, 3
    s_lshr_b32 s53, s53, s54
    s_and_b32 s53, s53, 0xff
    s_cmp_eq_u32 s53, s63
    s_cselect_b32 s53, 1, 0
    v_mov_b32 v4, 131072
    v_mov_b32 v5, s53
    ds_write_b32 v4, v5
    s_waitcnt lgkmcnt(0)
L_go_19:
    s_barrier
L_nobar_25:
    ds_read_b32 v14, v15
    s_add_u32 s52, s6, 3
    s_cmp_ge_u32 s52, s75
    s_cbranch_scc1 L_latepoll_27
L_nopoll_24:
    s_waitcnt lgkmcnt(0)
    v_readfirstlane_b32 s79, v14
    v_readlane_b32 s71, v32, s52
    s_bitcmp1_b64 s[68:69], s52
    s_cbranch_scc1 L_dq_28
    s_cmp_ge_u32 s52, s74
    s_cbranch_scc1 L_du_30
    s_cmp_eq_u32 s79, 1
    s_cbranch_scc1 L_fb1_32
    s_cmp_eq_u32 s79, 2
    s_cbranch_scc1 L_fb2_33
    s_mov_b32 m0, s70
    s_waitcnt vmcnt(4)
    buffer_load_dwordx4 v20, s[32:35], s71 offen offset:0 nt lds
    s_waitcnt vmcnt(4)
    buffer_load_dwordx4 v21, s[32:35], s71 offen offset:1024 nt lds
    s_waitcnt vmcnt(4)
    buffer_load_dwordx4 v22, s[32:35], s71 offen offset:2048 nt lds
    s_waitcnt vmcnt(4)
    buffer_load_dwordx4 v23, s[32:35], s71 offen offset:3072 nt lds
    s_add_u32 m0, m0, 16384
    s_waitcnt vmcnt(4)
    buffer_load_dwordx4 v24, s[36:39], s71 offen offset:0 nt lds
    s_waitcnt vmcnt(4)
    buffer_load_dwordx4 v25, s[36:39], s71 offen offset:1024 nt lds
    s_waitcnt vmcnt(4)
    buffer_load_dwordx4 v26, s[36:39], s71 offen offset:2048 nt lds
    s_waitcnt vmcnt(4)
    buffer_load_dwordx4 v27, s[36:39], s71 offen offset:3072 nt lds
    s_branch L_de_29
L_fb2_33:
    s_mov_b32 m0, s70
    s_waitcnt vmcnt(9)
    buffer_load_dwordx4 v20, s[32:35], s71 offen offset:0 nt lds
    s_waitcnt vmcnt(9)
    buffer_load_dwordx4 v21, s[32:35], s71 offen offset:1024 nt lds
    s_waitcnt vmcnt(9)
    buffer_load_dwordx4 v22, s[32:35], s71 offen offset:2048 nt lds
    s_waitcnt vmcnt(9)
    buffer_load_dwordx4 v23, s[32:35], s71 offen offset:3072 nt lds
    s_add_u32 m0, m0, 16384
    s_waitcnt vmcnt(9)
    buffer_load_dwordx4 v24, s[36:39], s71 offen offset:0 nt lds
    s_waitcnt vmcnt(9)
    buffer_load_dwordx4 v25, s[36:39], s71 offen offset:1024 nt lds
    s_waitcnt vmcnt(9)
    buffer_load_dwordx4 v26, s[36:39], s71 offen offset:2048 nt lds
    s_waitcnt vmcnt(9)
    buffer_load_dwordx4 v27, s[36:39], s71 offen offset:3072 nt lds
    s_branch L_de_29
L_fb1_32:
    s_mov_b32 m0, s70
    s_waitcnt vmcnt(5)
    buffer_load_dwordx4 v20, s[32:35], s71 offen offset:0 nt lds
    s_waitcnt vmcnt(5)
    buffer_load_dwordx4 v21, s[32:35], s71 offen offset:1024 nt lds
    s_waitcnt vmcnt(5)
    buffer_load_dwordx4 v22, s[32:35], s71 offen offset:2048 nt lds
    s_waitcnt vmcnt(5)
    buffer_load_dwordx4 v23, s[32:35], s71 offen offset:3072 nt lds
    s_add_u32 m0, m0, 16384
    s_waitcnt vmcnt(5)
    buffer_load_dwordx4 v24, s[36:39], s71 offen offset:0 nt lds
    s_waitcnt vmcnt(5)
    buffer_load_dwordx4 v25, s[36:39], s71 offen offset:1024 nt lds
    s_waitcnt vmcnt(5)
    buffer_load_dwordx4 v26, s[36:39], s71 offen offset:2048 nt lds
    s_waitcnt vmcnt(5)
    buffer_load_dwordx4 v27, s[36:39], s71 offen offset:3072 nt lds
    s_branch L_de_29
L_du_30:
    s_cmp_lg_u32 s79, 0
    s_cbranch_scc1 L_du2_34
    s_mov_b32 m0, s70
    s_waitcnt vmcnt(5)
    buffer_load_dwordx4 v20, s[32:35], s71 offen offset:0 nt lds
    s_waitcnt vmcnt(5)
    buffer_load_dwordx4 v21, s[32:35], s71 offen offset:1024 nt lds
    s_waitcnt vmcnt(5)
    buffer_load_dwordx4 v22, s[32:35], s71 offen offset:2048 nt lds
    s_waitcnt vmcnt(5)
    buffer_load_dwordx4 v23, s[32:35], s71 offen offset:3072 nt lds
    s_add_u32 m0, m0, 16384
    s_waitcnt vmcnt(5)
    buffer_load_dwordx4 v24, s[36:39], s71 offen offset:0 nt lds
    s_waitcnt vmcnt(5)
    buffer_load_dwordx4 v25, s[36:39], s71 offen offset:1024 nt lds
    s_waitcnt vmcnt(5)
    buffer_load_dwordx4 v26, s[36:39], s71 offen offset:2048 nt lds
    s_waitcnt vmcnt(5)
    buffer_load_dwordx4 v27, s[36:39], s71 offen offset:3072 nt lds
    s_branch L_de_29
L_du2_34:
    s_mov_b32 m0, s70
    s_nop 0
    buffer_load_dwordx4 v20, s[32:35], s71 offen offset:0 nt lds
    buffer_load_dwordx4 v21, s[32:35], s71 offen offset:1024 nt lds
    buffer_load_dwordx4 v22, s[32:35], s71 offen offset:2048 nt lds
    buffer_load_dwordx4 v23, s[32:35], s71 offen offset:3072 nt lds
    s_add_u32 m0, m0, 16384
    s_nop 0
    buffer_load_dwordx4 v24, s[36:39], s71 offen offset:0 nt lds
    buffer_load_dwordx4 v25, s[36:39], s71 offen offset:1024 nt lds
    buffer_load_dwordx4 v26, s[36:39], s71 offen offset:2048 nt lds
    buffer_load_dwordx4 v27, s[36:39], s71 offen offset:3072 nt lds
    s_branch L_de_29
L_dq_28:
    s_mov_b32 m0, s70
    s_waitcnt vmcnt(5)
    s_nop 0
    buffer_load_dwordx4 v28, s[40:43], s71 offen offset:0 lds
    s_waitcnt vmcnt(5)
    buffer_load_dwordx4 v29, s[40:43], s71 offen offset:1024 lds
    s_waitcnt vmcnt(5)
    buffer_load_dwordx4 v30, s[40:43], s71 offen offset:2048 lds
    s_waitcnt vmcnt(5)
    buffer_load_dwordx4 v31, s[40:43], s71 offen offset:3072 lds
    s_add_u32 m0, m0, 16384
    s_nop 0
    buffer_load_dwordx4 v28, s[44:47], s71 offen offset:0 lds
    buffer_load_dwordx4 v29, s[44:47], s71 offen offset:1024 lds
    buffer_load_dwordx4 v30, s[44:47], s71 offen offset:2048 lds
    buffer_load_dwordx4 v31, s[44:47], s71 offen offset:3072 lds
L_de_29:
    s_add_u32 s70, s70, 32768
    s_cmp_ge_u32 s70, 131072
    s_cselect_b32 s70, s72, s70
    s_branch L_skipdma_23
L_latepoll_27:
    s_add_u32 s53, s7, 1
    s_cmp_lg_u32 s52, s53
    s_cbranch_scc1 L_skipdma_23
    s_cmp_eq_u32 s66, 0
    s_cbranch_scc1 L_skipdma_23
    v_mov_b32 v37, 0
    s_mov_b64 exec, 1
    buffer_atomic_add v37, off, s[28:31], s73 sc0 sc1
    s_mov_b64 exec, -1
L_skipdma_23:
    s_add_u32 s6, s6, 1
    s_cmp_lt_u32 s6, s75
    s_cbranch_scc1 L_ploop_18
    s_cmp_eq_u32 s63, 0
    s_cbranch_scc1 L_pend_35
    v_mov_b32 v4, 131072
    ds_read_b32 v5, v4
    s_waitcnt lgkmcnt(0)
    v_readfirstlane_b32 s52, v5
    s_cmp_eq_u32 s52, 1
    s_cbranch_scc1 L_pend_35
    s_cmp_lg_u32 s3, 0
    s_cbranch_scc1 L_barx_36
    s_mov_b32 s55, 64
L_spin_37:
    v_mov_b32 v37, 0
    s_mov_b64 exec, 1
    buffer_atomic_add v37, off, s[28:31], s73 sc0 sc1
    s_mov_b64 exec, -1
    s_waitcnt vmcnt(0)
    v_readfirstlane_b32 s53, v37
    s_and_b32 s54, s5, 3
    s_lshl_b32 s54, s54, 3
    s_lshr_b32 s53, s53, s54
    s_and_b32 s53, s53, 0xff
    s_cmp_eq_u32 s53, s63
    s_cselect_b32 s56, 1, 2
    s_cbranch_scc1 L_spindone_38
    s_sub_u32 s55, s55, 1
    s_cmp_lg_u32 s55, 0
    s_cbranch_scc1 L_spin_37
L_spindone_38:
    v_mov_b32 v5, s56
    ds_write_b32 v4, v5 offset:4
    s_waitcnt lgkmcnt(0)
L_barx_36:
    s_barrier
    ds_read_b32 v5, v4 offset:4
    s_waitcnt lgkmcnt(0)
    v_readfirstlane_b32 s52, v5
    s_cmp_eq_u32 s52, 1
    s_cbranch_scc1 L_pend_35
    s_sub_u32 s52, s7, 1
    s_sub_u32 s7, s64, s52
    s_lshl_b32 s52, s52, 1
    v_add_u32 v4, s52, v38
    v_min_u32 v4, 0x7f, v4
    s_lshl_b32 s52, s5, 9
    v_lshl_add_u32 v4, v4, 2, s52
    buffer_load_dword v32, v4, s[48:51], 0 offen
    s_mov_b64 s[68:69], 0
    s_mov_b32 s63, 0
    s_lshl_b32 s53, s4, 9
    s_waitcnt vmcnt(0)
    v_lshl_add_u32 v32, v32, 16, s53
    s_nop 0
    v_readlane_b32 s71, v32, 0
    s_add_u32 m0, s72, 0
    s_nop 3
    buffer_load_dwordx4 v20, s[32:35], s71 offen offset:0 nt lds
    buffer_load_dwordx4 v21, s[32:35], s71 offen offset:1024 nt lds
    buffer_load_dwordx4 v22, s[32:35], s71 offen offset:2048 nt lds
    buffer_load_dwordx4 v23, s[32:35], s71 offen offset:3072 nt lds
    s_add_u32 m0, m0, 16384
    s_nop 0
    buffer_load_dwordx4 v24, s[36:39], s71 offen offset:0 nt lds
    buffer_load_dwordx4 v25, s[36:39], s71 offen offset:1024 nt lds
    buffer_load_dwordx4 v26, s[36:39], s71 offen offset:2048 nt lds
    buffer_load_dwordx4 v27, s[36:39], s71 offen offset:3072 nt lds
    s_cmp_le_u32 s7, 1
    s_cbranch_scc1 L_ploop0_2
    v_readlane_b32 s71, v32, 1
    s_add_u32 m0, s72, 32768
    s_nop 3
    buffer_load_dwordx4 v20, s[32:35], s71 offen offset:0 nt lds
    buffer_load_dwordx4 v21, s[32:35], s71 offen offset:1024 nt lds
    buffer_load_dwordx4 v22, s[32:35], s71 offen offset:2048 nt lds
    buffer_load_dwordx4 v23, s[32:35], s71 offen offset:3072 nt lds
    s_add_u32 m0, m0, 16384
    s_nop 0
    buffer_load_dwordx4 v24, s[36:39], s71 offen offset:0 nt lds
    buffer_load_dwordx4 v25, s[36:39], s71 offen offset:1024 nt lds
    buffer_load_dwordx4 v26, s[36:39], s71 offen offset:2048 nt lds
    buffer_load_dwordx4 v27, s[36:39], s71 offen offset:3072 nt lds
    s_cmp_le_u32 s7, 2
    s_cbranch_scc1 L_ploop0_2
    v_readlane_b32 s71, v32, 2
    s_add_u32 m0, s72, 65536
    s_nop 3
    buffer_load_dwordx4 v20, s[32:35], s71 offen offset:0 nt lds
    buffer_load_dwordx4 v21, s[32:35], s71 offen offset:1024 nt lds
    buffer_load_dwordx4 v22, s[32:35], s71 offen offset:2048 nt lds
    buffer_load_dwordx4 v23, s[32:35], s71 offen offset:3072 nt lds
    s_add_u32 m0, m0, 16384
    s_nop 0
    buffer_load_dwordx4 v24, s[36:39], s71 offen offset:0 nt lds
    buffer_load_dwordx4 v25, s[36:39], s71 offen offset:1024 nt lds
    buffer_load_dwordx4 v26, s[36:39], s71 offen offset:2048 nt lds
    buffer_load_dwordx4 v27, s[36:39], s71 offen offset:3072 nt lds
    s_branch L_ploop0_2
L_pend_35:
    s_endpgm
L_consumer:
    v_and_b32 v2, 15, v1
    v_lshrrev_b32 v3, 4, v1
    v_xor_b32 v4, v3, v2
    v_lshlrev_b32 v4, 4, v4
    v_lshl_add_u32 v14, v2, 9, v4
    v_lshrrev_b32 v4, 2, v2
    v_lshl_add_u32 v4, v3, 2, v4
    v_and_b32 v5, 7, v4
    v_lshlrev_b32 v5, 5, v5
    v_lshl_add_u32 v5, v4, 9, v5
    v_and_b32 v6, 3, v1
    v_lshl_add_u32 v5, v6, 3, v5
    s_and_b32 s52, s3, 1
    s_lshl_b32 s52, s52, 8
    s_add_u32 s53, s52, 16384
    v_add_u32 v15, s53, v5
    v_lshrrev_b32 v4, 1, v3
    v_and_b32 v5, 1, v3
    v_lshlrev_b32 v4, 2, v4
    v_lshl_add_u32 v16, v5, 1, v4
    s_lshl_b32 s53, s3, 12
    v_lshl_add_u32 v17, v1, 4, s53
    s_lshl_b32 s53, s3, 9
    s_add_u32 s53, s53, 16384
    v_lshl_add_u32 v18, v1, 3, s53
    v_lshlrev_b32 v19, 9, v2
    v_bfe_u32 v4, v1, 4, 1
    v_lshl_add_u32 v19, v4, 5, v19
    v_bfe_u32 v4, v1, 5, 1
    v_lshl_add_u32 v19, v4, 4, v19
    v_add_u32 v19, s52, v19
    s_mov_b32 s71, 0x3db8aa3b
    v_lshlrev_b32 v3, 2, v1
    s_waitcnt lgkmcnt(0)
    s_mov_b32 s24, s16
    s_mov_b32 s25, s17
    s_mov_b32 s26, 0x40
    s_mov_b32 s27, 0x20000
    buffer_load_dword v104, v3, s[24:27], 0 offen
    s_mov_b32 s32, s22
    s_mov_b32 s33, s23
    s_mov_b32 s34, 0x20100000
    s_mov_b32 s35, 0x20000
    s_mov_b32 s36, s18
    s_mov_b32 s37, s19
    s_mov_b32 s38, 0x200000
    s_mov_b32 s39, 0x20000
    s_mov_b32 s28, s20
    s_mov_b32 s29, s21
    s_mov_b32 s30, 0x100
    s_mov_b32 s31, 0x20000
    s_mov_b32 s72, 0
    s_mov_b32 s74, 0
    s_waitcnt vmcnt(0)
    v_max_i32 v104, 0, v104
    v_add_u32 v105, -1, v104
    v_min_u32 v105, 0x7ff, v105
    v_lshrrev_b32 v105, 5, v105
    v_add_u32 v105, 1, v105
    v_mov_b32 v106, v105
    s_nop 1
    v_add_u32_dpp v106, v106, v106 row_shr:1 row_mask:0xf bank_mask:0xf bound_ctrl:1
    s_nop 1
    v_add_u32_dpp v106, v106, v106 row_shr:2 row_mask:0xf bank_mask:0xf bound_ctrl:1
    s_nop 1
    v_add_u32_dpp v106, v106, v106 row_shr:4 row_mask:0xf bank_mask:0xf bound_ctrl:1
    s_nop 1
    v_add_u32_dpp v106, v106, v106 row_shr:8 row_mask:0xf bank_mask:0xf bound_ctrl:1
    s_nop 0
    v_readlane_b32 s52, v106, 15
    s_mov_b32 s66, 0xffff
    s_add_u32 s52, s52, 95
    s_lshr_b32 s57, s52, 5
L_refine_39:
    v_cmp_le_u32 vcc, s57, v105
    s_and_b32 s52, vcc_lo, s66
    s_cmp_eq_u32 s52, s66
    s_cbranch_scc1 L_refdone_40
    s_mov_b32 s66, s52
    s_bcnt1_i32_b32 s53, s66
    s_mov_b32 vcc_lo, s66
    s_add_u32 s53, s53, 16
    v_cndmask_b32 v106, 0, v105, vcc
    v_cvt_f32_u32 v2, s53
    s_nop 0
    v_add_u32_dpp v106, v106, v106 row_shr:1 row_mask:0xf bank_mask:0xf bound_ctrl:1
    s_nop 1
    v_add_u32_dpp v106, v106, v106 row_shr:2 row_mask:0xf bank_mask:0xf bound_ctrl:1
    s_nop 1
    v_add_u32_dpp v106, v106, v106 row_shr:4 row_mask:0xf bank_mask:0xf bound_ctrl:1
    s_nop 1
    v_add_u32_dpp v106, v106, v106 row_shr:8 row_mask:0xf bank_mask:0xf bound_ctrl:1
    v_rcp_f32 v2, v2
    v_readlane_b32 s52, v106, 15
    s_lshl1_add_u32 s52, s53, s52
    s_add_u32 s52, s52, 31
    v_cvt_f32_u32 v3, s52
    v_add_f32 v3, 0.5, v3
    v_mul_f32 v3, v3, v2
    v_cvt_u32_f32 v3, v3
    s_nop 0
    v_readfirstlane_b32 s52, v3
    s_max_u32 s57, s57, s52
    s_branch L_refine_39
L_refdone_40:
    s_max_u32 s57, s57, 3
    s_min_u32 s57, s57, 63
    v_subrev_u32 v107, s57, v105
    v_cmp_lt_u32 vcc, s57, v105
    v_add_u32 v107, 1, v107
    s_nop 0
    v_cndmask_b32 v107, 0, v107, vcc
    v_mov_b32 v106, v107
    s_nop 1
    v_add_u32_dpp v106, v106, v106 row_shr:1 row_mask:0xf bank_mask:0xf bound_ctrl:1
    s_nop 1
    v_add_u32_dpp v106, v106, v106 row_shr:2 row_mask:0xf bank_mask:0xf bound_ctrl:1
    s_nop 1
    v_add_u32_dpp v106, v106, v106 row_shr:4 row_mask:0xf bank_mask:0xf bound_ctrl:1
    s_nop 1
    v_add_u32_dpp v106, v106, v106 row_shr:8 row_mask:0xf bank_mask:0xf bound_ctrl:1
    s_nop 0
    v_readlane_b32 s58, v106, 15
    s_cmp_ge_u32 s5, 16
    s_cbranch_scc1 L_cC_41
    v_readlane_b32 s64, v105, s5
    v_readlane_b32 s52, v106, s5
    v_readlane_b32 s53, v107, s5
    v_mul_u32_u24 v2, s58, v1
    s_min_u32 s7, s64, s57
    v_add_u32 v3, s58, v2
    s_add_u32 s7, s7, 1
    v_lshrrev_b32 v2, 4, v2
    s_sub_u32 s53, s52, s53
    s_add_u32 s53, s53, 1
    v_lshrrev_b32 v3, 4, v3
    v_max_u32 v2, s53, v2
    v_min_u32 v3, s52, v3
    v_cmp_lt_u32 vcc, v2, v3
    s_mov_b64 s[68:69], 1
    s_and_b32 s62, vcc_lo, 0xffff
    s_bcnt1_i32_b32 s63, s62
    v_readlane_b32 s52, v104, s5
    v_mov_b32 v10, s5
    v_add_u32 v11, -1, v1
    v_mov_b32 v12, s52
    s_branch L_ctab0_45
L_cC_41:
    v_mov_b32 v4, 131080
    v_mov_b32 v5, 0
    ds_write_b32 v4, v5
    s_sub_u32 s52, s5, 16
    s_mul_i32 s59, s52, s58
    s_add_u32 s60, s59, s58
    s_lshr_b32 s59, s59, 4
    s_lshr_b32 s60, s60, 4
    s_cmp_eq_u32 s59, s60
    s_cbranch_scc1 L_end
    v_cmp_ge_u32 vcc, s59, v106
    s_mov_b32 s65, 0
    s_mov_b64 s[68:69], 0
    s_mov_b32 s62, 0
    s_mov_b32 s63, 0
    s_and_b32 s52, vcc_lo, 0xffff
    s_bcnt1_i32_b32 s61, s52
L_seg_43:
    v_readlane_b32 s52, v107, s61
    v_readlane_b32 s53, v106, s61
    v_readlane_b32 s54, v104, s61
    v_cmp_le_u32 vcc, s65, v1
    s_sub_u32 s52, s53, s52
    s_add_u32 s52, s52, 1
    s_max_u32 s55, s52, s59
    s_min_u32 s56, s53, s60
    s_cmp_ge_u32 s55, s56
    s_cbranch_scc1 L_segnext_44
    s_sub_u32 s52, s55, s52
    s_add_u32 s52, s52, s57
    s_sub_u32 s52, s52, s65
    s_sub_u32 s52, s52, 1
    v_mov_b32 v2, s61
    v_mov_b32 v3, s52
    v_mov_b32 v4, s54
    v_cndmask_b32 v10, v10, v2, vcc
    v_cndmask_b32 v11, v11, v3, vcc
    v_cndmask_b32 v12, v12, v4, vcc
    s_bitset1_b64 s[68:69], s65
    s_sub_u32 s56, s56, s55
    s_add_u32 s65, s65, s56
    s_add_u32 s65, s65, 1
L_segnext_44:
    s_add_u32 s61, s61, 1
    s_cmp_lt_u32 s53, s60
    s_cbranch_scc1 L_seg_43
    s_mov_b32 s7, s65
    s_cmp_eq_u32 s65, 0
    s_cbranch_scc1 L_end
    v_add_u32 v11, v11, v1
    s_waitcnt lgkmcnt(0)
L_ctab0_45:
    v_mov_b32 v4, 131084
    v_mov_b32 v5, 1
    ds_write_b32 v4, v5
    s_lshr_b32 s79, s5, 4
    s_mul_i32 s79, s79, 64
    s_add_u32 s79, s79, 128
    s_lshr_b32 s52, s5, 1
    s_lshl_b32 s52, s52, 1
    s_add_u32 s52, s52, s4
    s_and_b32 s52, s52, 3
    s_add_u32 s52, s52, 2
    s_cmp_eq_u32 s3, 0
    s_cselect_b32 s77, s52, -2
    s_mov_b32 s78, -1
    s_mov_b32 s65, -1
    s_lshl_b32 s52, s7, 4
    s_sub_i32 s52, s58, s52
    s_add_i32 s52, s52, 14
    s_mul_i32 s52, s52, 32
    s_ashr_i32 s52, s52, 4
    s_add_i32 s52, s52, 0
    s_mov_b32 s53, 0
    s_bitcmp1_b32 s4, 0
    s_cselect_b32 s53, 2, -2
    s_sub_i32 s54, 2, s63
    s_mul_i32 s54, s54, 6
    s_add_i32 s53, s53, s54
    s_cmp_ge_u32 s5, 16
    s_cselect_b32 s80, s52, s53
    s_lshr_b32 s66, s58, 4
    s_sub_i32 s66, s66, 2
    v_cmp_le_u32 vcc, s57, v105
    s_sub_i32 s53, s7, 5
    s_cmp_gt_u32 s7, s57
    s_cselect_b32 s53, s53, -1
    s_and_b32 s54, vcc_lo, 0xffff
    s_bcnt1_i32_b32 s54, s54
    s_mul_i32 s54, s54, 2
    s_cmp_ge_u32 s5, 16
    s_cselect_b32 s66, s66, s53
    s_cselect_b32 s59, 32, s54
    s_mul_i32 s53, s59, 3
    s_lshr_b32 s53, s53, 1
    s_sub_i32 s80, s80, s53
    s_cmp_gt_i32 s77, s66
    s_cselect_b32 s77, -2, s77
    s_waitcnt lgkmcnt(0)
L_ctab_42:
    v_lshlrev_b32 v4, 5, v11
    v_sub_u32 v20, v12, v4
    v_cmp_gt_i32 s[82:83], 32, v20
    s_mov_b32 s6, 0
    s_mov_b32 s70, 0
L_cloop_57:
    s_barrier
    v_add_u32 v22, s70, v14
    s_cmp_lg_u32 s72, 2
    s_cbranch_scc1 L_nosig_60
    s_cmp_lg_u32 s3, 0
    s_cbranch_scc1 L_sig_61
    s_lshl_b32 s52, s4, 4
    s_add_u32 s52, s52, s73
    s_and_b32 s53, s52, 3
    s_lshl_b32 s53, s53, 3
    s_lshl_b32 s53, 1, s53
    s_and_b32 s52, s52, 0x7c
    v_mov_b32 v9, s53
    s_mov_b64 exec, 1
    buffer_atomic_add v9, off, s[28:31], s52 sc1
    s_mov_b64 exec, -1
L_sig_61:
    s_mov_b32 s72, 0
L_nosig_60:
    s_cmp_lg_u32 s6, s77
    s_cbranch_scc1 L_nofb_62
    v_mov_b32 v13, 1
    s_mov_b64 exec, 1
    buffer_atomic_add v13, off, s[28:31], s79 sc0 sc1
    s_mov_b64 exec, -1
    s_add_u32 s78, s6, 0
    s_add_u32 s77, s6, 4
    s_cmp_gt_i32 s77, s66
    s_cselect_b32 s77, -2, s77
L_nofb_62:
    s_bitcmp1_b64 s[68:69], s6
    s_cbranch_scc1 L_pseudo_59
    v_xor_b32 v23, 64, v22
    v_xor_b32 v24, 128, v22
    v_xor_b32 v25, 192, v22
    s_add_u32 s52, s6, 1
    s_cmp_lg_u32 s52, s7
    s_cbranch_scc1 L_noearly_63
    s_cmp_eq_u32 s63, 0
    s_cbranch_scc1 L_noearly_63
    v_mov_b32 v4, 131072
    ds_read_b32 v5, v4
    s_waitcnt lgkmcnt(0)
    v_readfirstlane_b32 s74, v5
    s_cmp_lg_u32 s74, 1
    s_cbranch_scc1 L_noearly_63
    s_mov_b32 s75, 0
    s_ff1_i32_b32 s52, s62
    s_bitset0_b32 s62, s52
    s_lshl_b32 s53, s4, 5
    s_add_u32 s52, s52, s53
    s_add_u32 s52, s52, s5
    s_lshl_b32 s52, s52, 15
    buffer_load_dwordx2 v[244:245], v18, s[32:35], s52 offen sc1
    buffer_load_dwordx4 v[196:199], v17, s[32:35], s52 offen offset:0 sc1
    buffer_load_dwordx4 v[200:203], v17, s[32:35], s52 offen offset:1024 sc1
    buffer_load_dwordx4 v[204:207], v17, s[32:35], s52 offen offset:2048 sc1
    buffer_load_dwordx4 v[208:211], v17, s[32:35], s52 offen offset:3072 sc1
    s_add_u32 s75, s75, 1
    s_cmp_eq_u32 s62, 0
    s_cbranch_scc1 L_ipd_64
    s_ff1_i32_b32 s52, s62
    s_bitset0_b32 s62, s52
    s_lshl_b32 s53, s4, 5
    s_add_u32 s52, s52, s53
    s_add_u32 s52, s52, s5
    s_lshl_b32 s52, s52, 15
    buffer_load_dwordx2 v[246:247], v18, s[32:35], s52 offen sc1
    buffer_load_dwordx4 v[212:215], v17, s[32:35], s52 offen offset:0 sc1
    buffer_load_dwordx4 v[216:219], v17, s[32:35], s52 offen offset:1024 sc1
    buffer_load_dwordx4 v[220:223], v17, s[32:35], s52 offen offset:2048 sc1
    buffer_load_dwordx4 v[224:227], v17, s[32:35], s52 offen offset:3072 sc1
    s_add_u32 s75, s75, 1
    s_cmp_eq_u32 s62, 0
    s_cbranch_scc1 L_ipd_64
    s_ff1_i32_b32 s52, s62
    s_bitset0_b32 s62, s52
    s_lshl_b32 s53, s4, 5
    s_add_u32 s52, s52, s53
    s_add_u32 s52, s52, s5
    s_lshl_b32 s52, s52, 15
    buffer_load_dwordx2 v[248:249], v18, s[32:35], s52 offen sc1
    buffer_load_dwordx4 v[228:231], v17, s[32:35], s52 offen offset:0 sc1
    buffer_load_dwordx4 v[232:235], v17, s[32:35], s52 offen offset:1024 sc1
    buffer_load_dwordx4 v[236:239], v17, s[32:35], s52 offen offset:2048 sc1
    buffer_load_dwordx4 v[240:243], v17, s[32:35], s52 offen offset:3072 sc1
    s_add_u32 s75, s75, 1
L_ipd_64:
L_noearly_63:
    ds_read_b128 v[104:107], v22 offset:0
    ds_read_b128 v[108:111], v22 offset:8192
    ds_read_b128 v[112:115], v23 offset:0
    ds_read_b128 v[116:119], v23 offset:8192
    ds_read_b128 v[120:123], v24 offset:0
    ds_read_b128 v[124:127], v24 offset:8192
    ds_read_b128 v[128:131], v25 offset:0
    ds_read_b128 v[132:135], v25 offset:8192
    ds_read_b128 v[136:139], v22 offset:256
    ds_read_b128 v[140:143], v22 offset:8448
    ds_read_b128 v[144:147], v23 offset:256
    ds_read_b128 v[148:151], v23 offset:8448
    v_add_u32 v26, s70, v15
    v_xor_b32 v27, 32, v26
    v_xor_b32 v28, 64, v26
    v_xor_b32 v29, 96, v26
    v_xor_b32 v30, 128, v26
    v_xor_b32 v31, 160, v26
    v_xor_b32 v32, 192, v26
    v_xor_b32 v33, 224, v26
    s_waitcnt lgkmcnt(10)
    v_mfma_f32_16x16x32_bf16 v[184:187], v[104:107], v[40:43], 0
    v_mfma_f32_16x16x32_bf16 v[188:191], v[108:111], v[40:43], 0
    ds_read_b128 v[104:107], v24 offset:256
    ds_read_b128 v[108:111], v24 offset:8448
    s_waitcnt lgkmcnt(10)
    v_mfma_f32_16x16x32_bf16 v[184:187], v[112:115], v[44:47], v[184:187]
    v_mfma_f32_16x16x32_bf16 v[188:191], v[116:119], v[44:47], v[188:191]
    ds_read_b128 v[112:115], v25 offset:256
    ds_read_b128 v[116:119], v25 offset:8448
    s_waitcnt lgkmcnt(10)
    v_mfma_f32_16x16x32_bf16 v[184:187], v[120:123], v[48:51], v[184:187]
    v_mfma_f32_16x16x32_bf16 v[188:191], v[124:127], v[48:51], v[188:191]
    ds_read_b64_tr_b16 v[152:153], v26 offset:0
    ds_read_b64_tr_b16 v[154:155], v26 offset:8192
    s_waitcnt lgkmcnt(10)
    v_mfma_f32_16x16x32_bf16 v[184:187], v[128:131], v[52:55], v[184:187]
    v_mfma_f32_16x16x32_bf16 v[188:191], v[132:135], v[52:55], v[188:191]
    ds_read_b64_tr_b16 v[156:157], v27 offset:0
    ds_read_b64_tr_b16 v[158:159], v27 offset:8192
    s_waitcnt lgkmcnt(10)
    v_mfma_f32_16x16x32_bf16 v[184:187], v[136:139], v[56:59], v[184:187]
    v_mfma_f32_16x16x32_bf16 v[188:191], v[140:143], v[56:59], v[188:191]
    ds_read_b64_tr_b16 v[160:161], v28 offset:0
    ds_read_b64_tr_b16 v[162:163], v28 offset:8192
    s_waitcnt lgkmcnt(10)
    v_mfma_f32_16x16x32_bf16 v[184:187], v[144:147], v[60:63], v[184:187]
    v_mfma_f32_16x16x32_bf16 v[188:191], v[148:151], v[60:63], v[188:191]
    ds_read_b64_tr_b16 v[164:165], v29 offset:0
    ds_read_b64_tr_b16 v[166:167], v29 offset:8192
    s_waitcnt lgkmcnt(10)
    v_mfma_f32_16x16x32_bf16 v[184:187], v[104:107], v[64:67], v[184:187]
    v_mfma_f32_16x16x32_bf16 v[188:191], v[108:111], v[64:67], v[188:191]
    ds_read_b64_tr_b16 v[168:169], v30 offset:0
    ds_read_b64_tr_b16 v[170:171], v30 offset:8192
    ds_read_b64_tr_b16 v[172:173], v31 offset:0
    ds_read_b64_tr_b16 v[174:175], v31 offset:8192
    s_waitcnt lgkmcnt(12)
    v_mfma_f32_16x16x32_bf16 v[184:187], v[112:115], v[68:71], v[184:187]
    v_mfma_f32_16x16x32_bf16 v[188:191], v[116:119], v[68:71], v[188:191]
    ds_read_b64_tr_b16 v[176:177], v32 offset:0
    ds_read_b64_tr_b16 v[178:179], v32 offset:8192
    ds_read_b64_tr_b16 v[180:181], v33 offset:0
    ds_read_b64_tr_b16 v[182:183], v33 offset:8192
    s_bitcmp1_b64 s[82:83], s6
    s_cbranch_scc0 L_nomask_65
    v_readlane_b32 s52, v20, s6
    v_mov_b32 v4, 0xd0800000
    s_sub_i32 s53, s52, 0
    v_cmp_gt_i32 vcc, s53, v16
    s_nop 1
    v_cndmask_b32 v184, v4, v184, vcc
    s_sub_i32 s53, s52, 8
    v_cmp_gt_i32 vcc, s53, v16
    s_nop 1
    v_cndmask_b32 v185, v4, v185, vcc
    s_sub_i32 s53, s52, 1
    v_cmp_gt_i32 vcc, s53, v16
    s_nop 1
    v_cndmask_b32 v186, v4, v186, vcc
    s_sub_i32 s53, s52, 9
    v_cmp_gt_i32 vcc, s53, v16
    s_nop 1
    v_cndmask_b32 v187, v4, v187, vcc
    s_sub_i32 s53, s52, 16
    v_cmp_gt_i32 vcc, s53, v16
    s_nop 1
    v_cndmask_b32 v188, v4, v188, vcc
    s_sub_i32 s53, s52, 24
    v_cmp_gt_i32 vcc, s53, v16
    s_nop 1
    v_cndmask_b32 v189, v4, v189, vcc
    s_sub_i32 s53, s52, 17
    v_cmp_gt_i32 vcc, s53, v16
    s_nop 1
    v_cndmask_b32 v190, v4, v190, vcc
    s_sub_i32 s53, s52, 25
    v_cmp_gt_i32 vcc, s53, v16
    s_nop 1
    v_cndmask_b32 v191, v4, v191, vcc
L_nomask_65:
    s_nop 0
    v_max3_f32 v2, v184, v185, v186
    v_max3_f32 v3, v188, v189, v190
    v_max3_f32 v2, v2, v187, v38
    v_max3_f32 v2, v2, v3, v191
    v_mov_b32 v3, v2
    s_nop 1
    v_permlane16_swap_b32 v2, v3
    v_max_f32 v2, v2, v3
    v_mov_b32 v3, v2
    s_nop 1
    v_permlane32_swap_b32 v2, v3
    v_max_f32 v2, v2, v3
    v_mul_f32 v3, s71, v2
    v_mov_b32 v38, v2
    v_fma_f32 v184, v184, s71, -v3
    v_fma_f32 v185, v185, s71, -v3
    v_fma_f32 v186, v186, s71, -v3
    v_fma_f32 v187, v187, s71, -v3
    v_fma_f32 v188, v188, s71, -v3
    v_fma_f32 v189, v189, s71, -v3
    v_fma_f32 v190, v190, s71, -v3
    v_fma_f32 v191, v191, s71, -v3
    v_sub_f32 v36, v34, v3
    v_cmp_neq_f32 vcc, v34, v3
    v_mov_b32 v34, v3
    v_exp_f32 v184, v184
    v_exp_f32 v185, v185
    v_exp_f32 v186, v186
    v_exp_f32 v187, v187
    v_cvt_pk_bf16_f32 v192, v184, v185
    v_exp_f32 v188, v188
    v_exp_f32 v189, v189
    v_cvt_pk_bf16_f32 v193, v186, v187
    v_exp_f32 v190, v190
    v_exp_f32 v191, v191
    v_cvt_pk_bf16_f32 v194, v188, v189
    v_exp_f32 v36, v36
    v_cvt_pk_bf16_f32 v195, v190, v191
    s_cbranch_vccz L_keep_66
    v_pk_mul_f32 v[72:73], v[72:73], v[36:37] op_sel_hi:[1,0]
    v_pk_mul_f32 v[74:75], v[74:75], v[36:37] op_sel_hi:[1,0]
    v_pk_mul_f32 v[76:77], v[76:77], v[36:37] op_sel_hi:[1,0]
    v_pk_mul_f32 v[78:79], v[78:79], v[36:37] op_sel_hi:[1,0]
    s_waitcnt lgkmcnt(0)
    v_mfma_f32_16x16x32_bf16 v[72:75], v[152:155], v[192:195], v[72:75]
    v_pk_mul_f32 v[80:81], v[80:81], v[36:37] op_sel_hi:[1,0]
    v_pk_mul_f32 v[82:83], v[82:83], v[36:37] op_sel_hi:[1,0]
    v_mfma_f32_16x16x32_bf16 v[76:79], v[156:159], v[192:195], v[76:79]
    v_pk_mul_f32 v[84:85], v[84:85], v[36:37] op_sel_hi:[1,0]
    v_pk_mul_f32 v[86:87], v[86:87], v[36:37] op_sel_hi:[1,0]
    v_mfma_f32_16x16x32_bf16 v[80:83], v[160:163], v[192:195], v[80:83]
    v_pk_mul_f32 v[88:89], v[88:89], v[36:37] op_sel_hi:[1,0]
    v_pk_mul_f32 v[90:91], v[90:91], v[36:37] op_sel_hi:[1,0]
    v_mfma_f32_16x16x32_bf16 v[84:87], v[164:167], v[192:195], v[84:87]
    v_pk_mul_f32 v[92:93], v[92:93], v[36:37] op_sel_hi:[1,0]
    v_pk_mul_f32 v[94:95], v[94:95], v[36:37] op_sel_hi:[1,0]
    v_mfma_f32_16x16x32_bf16 v[88:91], v[168:171], v[192:195], v[88:91]
    v_pk_mul_f32 v[96:97], v[96:97], v[36:37] op_sel_hi:[1,0]
    v_pk_mul_f32 v[98:99], v[98:99], v[36:37] op_sel_hi:[1,0]
    v_mfma_f32_16x16x32_bf16 v[92:95], v[172:175], v[192:195], v[92:95]
    v_pk_mul_f32 v[100:101], v[100:101], v[36:37] op_sel_hi:[1,0]
    v_pk_mul_f32 v[102:103], v[102:103], v[36:37] op_sel_hi:[1,0]
    v_mfma_f32_16x16x32_bf16 v[96:99], v[176:179], v[192:195], v[96:99]
    v_add_f32 v2, v184, v185
    v_add_f32 v3, v186, v187
    v_add_f32 v4, v188, v189
    v_add_f32 v5, v190, v191
    v_mfma_f32_16x16x32_bf16 v[100:103], v[180:183], v[192:195], v[100:103]
    v_add_f32 v2, v2, v3
    v_add_f32 v4, v4, v5
    v_add_f32 v2, v2, v4
    v_fma_f32 v35, v35, v36, v2
    s_branch L_pvdone_67
L_keep_66:
    s_waitcnt lgkmcnt(0)
    v_mfma_f32_16x16x32_bf16 v[72:75], v[152:155], v[192:195], v[72:75]
    v_add_f32 v2, v184, v185
    v_add_f32 v3, v186, v187
    v_mfma_f32_16x16x32_bf16 v[76:79], v[156:159], v[192:195], v[76:79]
    v_add_f32 v4, v188, v189
    v_add_f32 v5, v190, v191
    v_mfma_f32_16x16x32_bf16 v[80:83], v[160:163], v[192:195], v[80:83]
    v_add_f32 v2, v2, v3
    v_add_f32 v4, v4, v5
    v_mfma_f32_16x16x32_bf16 v[84:87], v[164:167], v[192:195], v[84:87]
    v_add_f32 v2, v2, v4
    v_fma_f32 v35, v35, v36, v2
    v_mfma_f32_16x16x32_bf16 v[88:91], v[168:171], v[192:195], v[88:91]
    v_mfma_f32_16x16x32_bf16 v[92:95], v[172:175], v[192:195], v[92:95]
    v_mfma_f32_16x16x32_bf16 v[96:99], v[176:179], v[192:195], v[96:99]
    v_mfma_f32_16x16x32_bf16 v[100:103], v[180:183], v[192:195], v[100:103]
L_pvdone_67:
    s_cmp_lg_u32 s72, 1
    s_cbranch_scc1 L_adv_58
    s_waitcnt vmcnt(0)
    s_mov_b32 s72, 2
L_adv_58:
    s_cmp_lg_u32 s6, s65
    s_cbranch_scc1 L_nofbz_69
    v_mov_b32 v4, 131084
    v_mov_b32 v5, 1
    ds_write_b32 v4, v5
    s_waitcnt lgkmcnt(0)
L_nofbz_69:
    s_cmp_lt_u32 s6, s78
    s_cbranch_scc1 L_nofb2_68
    s_getreg_b32 s52, hwreg(HW_REG_IB_STS, 0, 4)
    s_add_u32 s53, s78, 2
    s_cmp_ge_u32 s6, s53
    s_cbranch_scc1 L_fbgo_70
    s_cmp_lg_u32 s52, 0
    s_cbranch_scc1 L_nofb2_68
L_fbgo_70:
    s_waitcnt vmcnt(0)
    v_readfirstlane_b32 s52, v13
    s_mul_i32 s53, s78, s59
    s_sub_i32 s52, s52, s53
    s_sub_i32 s52, s52, s80
    s_cmp_gt_i32 s52, 10
    s_cselect_b32 s53, 2, 1
    s_cselect_b32 s54, 64, 64
    s_cmp_lt_i32 s52, -10
    s_cselect_b32 s53, 0, s53
    s_cselect_b32 s54, 3, s54
    s_add_u32 s65, s6, s54
    v_mov_b32 v4, 131084
    v_mov_b32 v5, s53
    ds_write_b32 v4, v5
    s_mov_b32 s78, -1
    s_waitcnt lgkmcnt(0)
L_nofb2_68:
    s_add_u32 s70, s70, 32768
    s_cmp_eq_u32 s70, 131072
    s_cselect_b32 s70, 0, s70
    s_add_u32 s6, s6, 1
    s_cmp_lt_u32 s6, s7
    s_cbranch_scc1 L_cloop_57
    s_cmp_lt_u32 s5, 16
    s_cbranch_scc1 L_cF_71
    s_lshl_b32 s52, s4, 5
    s_add_u32 s52, s52, s61
    s_add_u32 s52, s52, s5
    s_sub_u32 s52, s52, 16
    s_lshl_b32 s52, s52, 15
    v_cvt_pk_bf16_f32 v152, v72, v73
    v_cvt_pk_bf16_f32 v153, v74, v75
    v_cvt_pk_bf16_f32 v154, v76, v77
    v_cvt_pk_bf16_f32 v155, v78, v79
    buffer_store_dwordx4 v[152:155], v17, s[32:35], s52 offen offset:0 sc1
    v_cvt_pk_bf16_f32 v156, v80, v81
    v_cvt_pk_bf16_f32 v157, v82, v83
    v_cvt_pk_bf16_f32 v158, v84, v85
    v_cvt_pk_bf16_f32 v159, v86, v87
    buffer_store_dwordx4 v[156:159], v17, s[32:35], s52 offen offset:1024 sc1
    v_cvt_pk_bf16_f32 v160, v88, v89
    v_cvt_pk_bf16_f32 v161, v90, v91
    v_cvt_pk_bf16_f32 v162, v92, v93
    v_cvt_pk_bf16_f32 v163, v94, v95
    buffer_store_dwordx4 v[160:163], v17, s[32:35], s52 offen offset:2048 sc1
    v_cvt_pk_bf16_f32 v164, v96, v97
    v_cvt_pk_bf16_f32 v165, v98, v99
    v_cvt_pk_bf16_f32 v166, v100, v101
    v_cvt_pk_bf16_f32 v167, v102, v103
    buffer_store_dwordx4 v[164:167], v17, s[32:35], s52 offen offset:3072 sc1
    buffer_store_dwordx2 v[34:35], v18, s[32:35], s52 offen sc1
    v_mov_b32 v4, 131080
    v_mov_b32 v5, 1
    s_waitcnt vmcnt(0)
    s_mov_b64 exec, 1
    ds_add_rtn_u32 v5, v4, v5
    s_waitcnt lgkmcnt(0)
    s_mov_b64 exec, -1
    v_readfirstlane_b32 s52, v5
    s_cmp_lg_u32 s52, 3
    s_cbranch_scc1 L_cend_72
    s_cmp_eq_u32 s72, 0
    s_cbranch_scc1 L_nop2_73
    s_lshl_b32 s52, s4, 4
    s_add_u32 s52, s52, s73
    s_and_b32 s53, s52, 3
    s_lshl_b32 s53, s53, 3
    s_lshl_b32 s53, 1, s53
    s_and_b32 s52, s52, 0x7c
    v_mov_b32 v9, s53
    s_mov_b64 exec, 1
    buffer_atomic_add v9, off, s[28:31], s52 sc1
    s_mov_b64 exec, -1
L_sig_74:
L_nop2_73:
    s_lshl_b32 s52, s4, 4
    s_add_u32 s52, s52, s61
    s_and_b32 s53, s52, 3
    s_lshl_b32 s53, s53, 3
    s_lshl_b32 s53, 1, s53
    s_and_b32 s52, s52, 0x7c
    v_mov_b32 v9, s53
    s_mov_b64 exec, 1
    buffer_atomic_add v9, off, s[28:31], s52 sc1
    s_mov_b64 exec, -1
L_sig_75:
    s_branch L_cend_72
L_pseudo_59:
    s_lshr_b32 s53, s3, 1
    s_lshl_b32 s53, s53, 13
    v_add_u32 v22, s53, v22
    v_xor_b32 v23, 64, v22
    v_xor_b32 v24, 128, v22
    v_xor_b32 v25, 192, v22
    ds_read_b128 v[40:43], v22 offset:0
    ds_read_b128 v[44:47], v23 offset:0
    ds_read_b128 v[48:51], v24 offset:0
    ds_read_b128 v[52:55], v25 offset:0
    ds_read_b128 v[56:59], v22 offset:256
    ds_read_b128 v[60:63], v23 offset:256
    ds_read_b128 v[64:67], v24 offset:256
    ds_read_b128 v[68:71], v25 offset:256
    s_cmp_eq_u32 s6, 0
    s_cbranch_scc1 L_first_76
    s_lshl_b32 s52, s4, 5
    s_add_u32 s52, s52, s61
    s_add_u32 s52, s52, s5
    s_sub_u32 s52, s52, 16
    s_lshl_b32 s52, s52, 15
    v_cvt_pk_bf16_f32 v152, v72, v73
    v_cvt_pk_bf16_f32 v153, v74, v75
    v_cvt_pk_bf16_f32 v154, v76, v77
    v_cvt_pk_bf16_f32 v155, v78, v79
    buffer_store_dwordx4 v[152:155], v17, s[32:35], s52 offen offset:0 sc1
    v_cvt_pk_bf16_f32 v156, v80, v81
    v_cvt_pk_bf16_f32 v157, v82, v83
    v_cvt_pk_bf16_f32 v158, v84, v85
    v_cvt_pk_bf16_f32 v159, v86, v87
    buffer_store_dwordx4 v[156:159], v17, s[32:35], s52 offen offset:1024 sc1
    v_cvt_pk_bf16_f32 v160, v88, v89
    v_cvt_pk_bf16_f32 v161, v90, v91
    v_cvt_pk_bf16_f32 v162, v92, v93
    v_cvt_pk_bf16_f32 v163, v94, v95
    buffer_store_dwordx4 v[160:163], v17, s[32:35], s52 offen offset:2048 sc1
    v_cvt_pk_bf16_f32 v164, v96, v97
    v_cvt_pk_bf16_f32 v165, v98, v99
    v_cvt_pk_bf16_f32 v166, v100, v101
    v_cvt_pk_bf16_f32 v167, v102, v103
    buffer_store_dwordx4 v[164:167], v17, s[32:35], s52 offen offset:3072 sc1
    buffer_store_dwordx2 v[34:35], v18, s[32:35], s52 offen sc1
    s_mov_b32 s72, 1
    s_mov_b32 s73, s61
L_first_76:
    v_readlane_b32 s61, v10, s6
    v_mov_b32 v72, 0
    v_mov_b32 v73, 0
    v_mov_b32 v74, 0
    v_mov_b32 v75, 0
    v_mov_b32 v76, 0
    v_mov_b32 v77, 0
    v_mov_b32 v78, 0
    v_mov_b32 v79, 0
    v_mov_b32 v80, 0
    v_mov_b32 v81, 0
    v_mov_b32 v82, 0
    v_mov_b32 v83, 0
    v_mov_b32 v84, 0
    v_mov_b32 v85, 0
    v_mov_b32 v86, 0
    v_mov_b32 v87, 0
    v_mov_b32 v88, 0
    v_mov_b32 v89, 0
    v_mov_b32 v90, 0
    v_mov_b32 v91, 0
    v_mov_b32 v92, 0
    v_mov_b32 v93, 0
    v_mov_b32 v94, 0
    v_mov_b32 v95, 0
    v_mov_b32 v96, 0
    v_mov_b32 v97, 0
    v_mov_b32 v98, 0
    v_mov_b32 v99, 0
    v_mov_b32 v100, 0
    v_mov_b32 v101, 0
    v_mov_b32 v102, 0
    v_mov_b32 v103, 0
    v_mov_b32 v34, 0xff800000
    v_mov_b32 v38, 0xff800000
    v_mov_b32 v35, 0
    s_waitcnt lgkmcnt(0)
    s_branch L_adv_58
L_cF_71:
    s_cmp_eq_u32 s63, 0
    s_cbranch_scc1 L_fin_77
    s_cmp_eq_u32 s74, 1
    s_cbranch_scc1 L_merge_51
    s_barrier
    v_mov_b32 v4, 131072
    ds_read_b32 v5, v4 offset:4
    s_waitcnt lgkmcnt(0)
    v_readfirstlane_b32 s52, v5
    s_cmp_eq_u32 s52, 1
    s_cbranch_scc1 L_issue_78
    s_sub_u32 s52, s7, 1
    s_sub_u32 s7, s64, s52
    v_add_u32 v11, s52, v1
    s_mov_b64 s[68:69], 0
    s_mov_b32 s63, 0
    s_branch L_ctab_42
L_issue_78:
    s_mov_b32 s75, 0
    s_ff1_i32_b32 s52, s62
    s_bitset0_b32 s62, s52
    s_lshl_b32 s53, s4, 5
    s_add_u32 s52, s52, s53
    s_add_u32 s52, s52, s5
    s_lshl_b32 s52, s52, 15
    buffer_load_dwordx2 v[244:245], v18, s[32:35], s52 offen sc1
    buffer_load_dwordx4 v[196:199], v17, s[32:35], s52 offen offset:0 sc1
    buffer_load_dwordx4 v[200:203], v17, s[32:35], s52 offen offset:1024 sc1
    buffer_load_dwordx4 v[204:207], v17, s[32:35], s52 offen offset:2048 sc1
    buffer_load_dwordx4 v[208:211], v17, s[32:35], s52 offen offset:3072 sc1
    s_add_u32 s75, s75, 1
    s_cmp_eq_u32 s62, 0
    s_cbranch_scc1 L_ipd_79
    s_ff1_i32_b32 s52, s62
    s_bitset0_b32 s62, s52
    s_lshl_b32 s53, s4, 5
    s_add_u32 s52, s52, s53
    s_add_u32 s52, s52, s5
    s_lshl_b32 s52, s52, 15
    buffer_load_dwordx2 v[246:247], v18, s[32:35], s52 offen sc1
    buffer_load_dwordx4 v[212:215], v17, s[32:35], s52 offen offset:0 sc1
    buffer_load_dwordx4 v[216:219], v17, s[32:35], s52 offen offset:1024 sc1
    buffer_load_dwordx4 v[220:223], v17, s[32:35], s52 offen offset:2048 sc1
    buffer_load_dwordx4 v[224:227], v17, s[32:35], s52 offen offset:3072 sc1
    s_add_u32 s75, s75, 1
    s_cmp_eq_u32 s62, 0
    s_cbranch_scc1 L_ipd_79
    s_ff1_i32_b32 s52, s62
    s_bitset0_b32 s62, s52
    s_lshl_b32 s53, s4, 5
    s_add_u32 s52, s52, s53
    s_add_u32 s52, s52, s5
    s_lshl_b32 s52, s52, 15
    buffer_load_dwordx2 v[248:249], v18, s[32:35], s52 offen sc1
    buffer_load_dwordx4 v[228:231], v17, s[32:35], s52 offen offset:0 sc1
    buffer_load_dwordx4 v[232:235], v17, s[32:35], s52 offen offset:1024 sc1
    buffer_load_dwordx4 v[236:239], v17, s[32:35], s52 offen offset:2048 sc1
    buffer_load_dwordx4 v[240:243], v17, s[32:35], s52 offen offset:3072 sc1
    s_add_u32 s75, s75, 1
L_ipd_79:
L_merge_51:
    s_cmp_eq_u32 s75, 3
    s_cbranch_scc1 L_mw_83
    s_cmp_eq_u32 s75, 2
    s_cbranch_scc1 L_mw_82
    s_waitcnt vmcnt(0)
    s_branch L_mw_81
L_mw_82:
    s_waitcnt vmcnt(5)
    s_branch L_mw_81
L_mw_83:
    s_waitcnt vmcnt(10)
L_mw_81:
    v_max_f32 v2, v34, v244
    v_sub_f32 v36, v34, v2
    v_sub_f32 v4, v244, v2
    v_mov_b32 v34, v2
    v_exp_f32 v36, v36
    v_exp_f32 v4, v4
    v_mul_f32 v35, v35, v36
    v_fmac_f32 v35, v245, v4
    v_lshlrev_b32 v184, 16, v196
    v_and_b32 v185, 0xffff0000, v196
    v_pk_mul_f32 v[72:73], v[72:73], v[36:37] op_sel_hi:[1,0]
    v_pk_fma_f32 v[72:73], v[184:185], v[4:5], v[72:73] op_sel_hi:[1,0,1]
    v_lshlrev_b32 v186, 16, v197
    v_and_b32 v187, 0xffff0000, v197
    v_pk_mul_f32 v[74:75], v[74:75], v[36:37] op_sel_hi:[1,0]
    v_pk_fma_f32 v[74:75], v[186:187], v[4:5], v[74:75] op_sel_hi:[1,0,1]
    v_lshlrev_b32 v188, 16, v198
    v_and_b32 v189, 0xffff0000, v198
    v_pk_mul_f32 v[76:77], v[76:77], v[36:37] op_sel_hi:[1,0]
    v_pk_fma_f32 v[76:77], v[188:189], v[4:5], v[76:77] op_sel_hi:[1,0,1]
    v_lshlrev_b32 v190, 16, v199
    v_and_b32 v191, 0xffff0000, v199
    v_pk_mul_f32 v[78:79], v[78:79], v[36:37] op_sel_hi:[1,0]
    v_pk_fma_f32 v[78:79], v[190:191], v[4:5], v[78:79] op_sel_hi:[1,0,1]
    v_lshlrev_b32 v184, 16, v200
    v_and_b32 v185, 0xffff0000, v200
    v_pk_mul_f32 v[80:81], v[80:81], v[36:37] op_sel_hi:[1,0]
    v_pk_fma_f32 v[80:81], v[184:185], v[4:5], v[80:81] op_sel_hi:[1,0,1]
    v_lshlrev_b32 v186, 16, v201
    v_and_b32 v187, 0xffff0000, v201
    v_pk_mul_f32 v[82:83], v[82:83], v[36:37] op_sel_hi:[1,0]
    v_pk_fma_f32 v[82:83], v[186:187], v[4:5], v[82:83] op_sel_hi:[1,0,1]
    v_lshlrev_b32 v188, 16, v202
    v_and_b32 v189, 0xffff0000, v202
    v_pk_mul_f32 v[84:85], v[84:85], v[36:37] op_sel_hi:[1,0]
    v_pk_fma_f32 v[84:85], v[188:189], v[4:5], v[84:85] op_sel_hi:[1,0,1]
    v_lshlrev_b32 v190, 16, v203
    v_and_b32 v191, 0xffff0000, v203
    v_pk_mul_f32 v[86:87], v[86:87], v[36:37] op_sel_hi:[1,0]
    v_pk_fma_f32 v[86:87], v[190:191], v[4:5], v[86:87] op_sel_hi:[1,0,1]
    v_lshlrev_b32 v184, 16, v204
    v_and_b32 v185, 0xffff0000, v204
    v_pk_mul_f32 v[88:89], v[88:89], v[36:37] op_sel_hi:[1,0]
    v_pk_fma_f32 v[88:89], v[184:185], v[4:5], v[88:89] op_sel_hi:[1,0,1]
    v_lshlrev_b32 v186, 16, v205
    v_and_b32 v187, 0xffff0000, v205
    v_pk_mul_f32 v[90:91], v[90:91], v[36:37] op_sel_hi:[1,0]
    v_pk_fma_f32 v[90:91], v[186:187], v[4:5], v[90:91] op_sel_hi:[1,0,1]
    v_lshlrev_b32 v188, 16, v206
    v_and_b32 v189, 0xffff0000, v206
    v_pk_mul_f32 v[92:93], v[92:93], v[36:37] op_sel_hi:[1,0]
    v_pk_fma_f32 v[92:93], v[188:189], v[4:5], v[92:93] op_sel_hi:[1,0,1]
    v_lshlrev_b32 v190, 16, v207
    v_and_b32 v191, 0xffff0000, v207
    v_pk_mul_f32 v[94:95], v[94:95], v[36:37] op_sel_hi:[1,0]
    v_pk_fma_f32 v[94:95], v[190:191], v[4:5], v[94:95] op_sel_hi:[1,0,1]
    v_lshlrev_b32 v184, 16, v208
    v_and_b32 v185, 0xffff0000, v208
    v_pk_mul_f32 v[96:97], v[96:97], v[36:37] op_sel_hi:[1,0]
    v_pk_fma_f32 v[96:97], v[184:185], v[4:5], v[96:97] op_sel_hi:[1,0,1]
    v_lshlrev_b32 v186, 16, v209
    v_and_b32 v187, 0xffff0000, v209
    v_pk_mul_f32 v[98:99], v[98:99], v[36:37] op_sel_hi:[1,0]
    v_pk_fma_f32 v[98:99], v[186:187], v[4:5], v[98:99] op_sel_hi:[1,0,1]
    v_lshlrev_b32 v188, 16, v210
    v_and_b32 v189, 0xffff0000, v210
    v_pk_mul_f32 v[100:101], v[100:101], v[36:37] op_sel_hi:[1,0]
    v_pk_fma_f32 v[100:101], v[188:189], v[4:5], v[100:101] op_sel_hi:[1,0,1]
    v_lshlrev_b32 v190, 16, v211
    v_and_b32 v191, 0xffff0000, v211
    v_pk_mul_f32 v[102:103], v[102:103], v[36:37] op_sel_hi:[1,0]
    v_pk_fma_f32 v[102:103], v[190:191], v[4:5], v[102:103] op_sel_hi:[1,0,1]
    s_cmp_le_u32 s75, 1
    s_cbranch_scc1 L_mdone_80
    s_cmp_eq_u32 s75, 3
    s_cbranch_scc1 L_mw_85
    s_waitcnt vmcnt(0)
    s_branch L_mw_84
L_mw_85:
    s_waitcnt vmcnt(5)
L_mw_84:
    v_max_f32 v2, v34, v246
    v_sub_f32 v36, v34, v2
    v_sub_f32 v4, v246, v2
    v_mov_b32 v34, v2
    v_exp_f32 v36, v36
    v_exp_f32 v4, v4
    v_mul_f32 v35, v35, v36
    v_fmac_f32 v35, v247, v4
    v_lshlrev_b32 v184, 16, v212
    v_and_b32 v185, 0xffff0000, v212
    v_pk_mul_f32 v[72:73], v[72:73], v[36:37] op_sel_hi:[1,0]
    v_pk_fma_f32 v[72:73], v[184:185], v[4:5], v[72:73] op_sel_hi:[1,0,1]
    v_lshlrev_b32 v186, 16, v213
    v_and_b32 v187, 0xffff0000, v213
    v_pk_mul_f32 v[74:75], v[74:75], v[36:37] op_sel_hi:[1,0]
    v_pk_fma_f32 v[74:75], v[186:187], v[4:5], v[74:75] op_sel_hi:[1,0,1]
    v_lshlrev_b32 v188, 16, v214
    v_and_b32 v189, 0xffff0000, v214
    v_pk_mul_f32 v[76:77], v[76:77], v[36:37] op_sel_hi:[1,0]
    v_pk_fma_f32 v[76:77], v[188:189], v[4:5], v[76:77] op_sel_hi:[1,0,1]
    v_lshlrev_b32 v190, 16, v215
    v_and_b32 v191, 0xffff0000, v215
    v_pk_mul_f32 v[78:79], v[78:79], v[36:37] op_sel_hi:[1,0]
    v_pk_fma_f32 v[78:79], v[190:191], v[4:5], v[78:79] op_sel_hi:[1,0,1]
    v_lshlrev_b32 v184, 16, v216
    v_and_b32 v185, 0xffff0000, v216
    v_pk_mul_f32 v[80:81], v[80:81], v[36:37] op_sel_hi:[1,0]
    v_pk_fma_f32 v[80:81], v[184:185], v[4:5], v[80:81] op_sel_hi:[1,0,1]
    v_lshlrev_b32 v186, 16, v217
    v_and_b32 v187, 0xffff0000, v217
    v_pk_mul_f32 v[82:83], v[82:83], v[36:37] op_sel_hi:[1,0]
    v_pk_fma_f32 v[82:83], v[186:187], v[4:5], v[82:83] op_sel_hi:[1,0,1]
    v_lshlrev_b32 v188, 16, v218
    v_and_b32 v189, 0xffff0000, v218
    v_pk_mul_f32 v[84:85], v[84:85], v[36:37] op_sel_hi:[1,0]
    v_pk_fma_f32 v[84:85], v[188:189], v[4:5], v[84:85] op_sel_hi:[1,0,1]
    v_lshlrev_b32 v190, 16, v219
    v_and_b32 v191, 0xffff0000, v219
    v_pk_mul_f32 v[86:87], v[86:87], v[36:37] op_sel_hi:[1,0]
    v_pk_fma_f32 v[86:87], v[190:191], v[4:5], v[86:87] op_sel_hi:[1,0,1]
    v_lshlrev_b32 v184, 16, v220
    v_and_b32 v185, 0xffff0000, v220
    v_pk_mul_f32 v[88:89], v[88:89], v[36:37] op_sel_hi:[1,0]
    v_pk_fma_f32 v[88:89], v[184:185], v[4:5], v[88:89] op_sel_hi:[1,0,1]
    v_lshlrev_b32 v186, 16, v221
    v_and_b32 v187, 0xffff0000, v221
    v_pk_mul_f32 v[90:91], v[90:91], v[36:37] op_sel_hi:[1,0]
    v_pk_fma_f32 v[90:91], v[186:187], v[4:5], v[90:91] op_sel_hi:[1,0,1]
    v_lshlrev_b32 v188, 16, v222
    v_and_b32 v189, 0xffff0000, v222
    v_pk_mul_f32 v[92:93], v[92:93], v[36:37] op_sel_hi:[1,0]
    v_pk_fma_f32 v[92:93], v[188:189], v[4:5], v[92:93] op_sel_hi:[1,0,1]
    v_lshlrev_b32 v190, 16, v223
    v_and_b32 v191, 0xffff0000, v223
    v_pk_mul_f32 v[94:95], v[94:95], v[36:37] op_sel_hi:[1,0]
    v_pk_fma_f32 v[94:95], v[190:191], v[4:5], v[94:95] op_sel_hi:[1,0,1]
    v_lshlrev_b32 v184, 16, v224
    v_and_b32 v185, 0xffff0000, v224
    v_pk_mul_f32 v[96:97], v[96:97], v[36:37] op_sel_hi:[1,0]
    v_pk_fma_f32 v[96:97], v[184:185], v[4:5], v[96:97] op_sel_hi:[1,0,1]
    v_lshlrev_b32 v186, 16, v225
    v_and_b32 v187, 0xffff0000, v225
    v_pk_mul_f32 v[98:99], v[98:99], v[36:37] op_sel_hi:[1,0]
    v_pk_fma_f32 v[98:99], v[186:187], v[4:5], v[98:99] op_sel_hi:[1,0,1]
    v_lshlrev_b32 v188, 16, v226
    v_and_b32 v189, 0xffff0000, v226
    v_pk_mul_f32 v[100:101], v[100:101], v[36:37] op_sel_hi:[1,0]
    v_pk_fma_f32 v[100:101], v[188:189], v[4:5], v[100:101] op_sel_hi:[1,0,1]
    v_lshlrev_b32 v190, 16, v227
    v_and_b32 v191, 0xffff0000, v227
    v_pk_mul_f32 v[102:103], v[102:103], v[36:37] op_sel_hi:[1,0]
    v_pk_fma_f32 v[102:103], v[190:191], v[4:5], v[102:103] op_sel_hi:[1,0,1]
    s_cmp_le_u32 s75, 2
    s_cbranch_scc1 L_mdone_80
    s_waitcnt vmcnt(0)
L_mw_86:
    v_max_f32 v2, v34, v248
    v_sub_f32 v36, v34, v2
    v_sub_f32 v4, v248, v2
    v_mov_b32 v34, v2
    v_exp_f32 v36, v36
    v_exp_f32 v4, v4
    v_mul_f32 v35, v35, v36
    v_fmac_f32 v35, v249, v4
    v_lshlrev_b32 v184, 16, v228
    v_and_b32 v185, 0xffff0000, v228
    v_pk_mul_f32 v[72:73], v[72:73], v[36:37] op_sel_hi:[1,0]
    v_pk_fma_f32 v[72:73], v[184:185], v[4:5], v[72:73] op_sel_hi:[1,0,1]
    v_lshlrev_b32 v186, 16, v229
    v_and_b32 v187, 0xffff0000, v229
    v_pk_mul_f32 v[74:75], v[74:75], v[36:37] op_sel_hi:[1,0]
    v_pk_fma_f32 v[74:75], v[186:187], v[4:5], v[74:75] op_sel_hi:[1,0,1]
    v_lshlrev_b32 v188, 16, v230
    v_and_b32 v189, 0xffff0000, v230
    v_pk_mul_f32 v[76:77], v[76:77], v[36:37] op_sel_hi:[1,0]
    v_pk_fma_f32 v[76:77], v[188:189], v[4:5], v[76:77] op_sel_hi:[1,0,1]
    v_lshlrev_b32 v190, 16, v231
    v_and_b32 v191, 0xffff0000, v231
    v_pk_mul_f32 v[78:79], v[78:79], v[36:37] op_sel_hi:[1,0]
    v_pk_fma_f32 v[78:79], v[190:191], v[4:5], v[78:79] op_sel_hi:[1,0,1]
    v_lshlrev_b32 v184, 16, v232
    v_and_b32 v185, 0xffff0000, v232
    v_pk_mul_f32 v[80:81], v[80:81], v[36:37] op_sel_hi:[1,0]
    v_pk_fma_f32 v[80:81], v[184:185], v[4:5], v[80:81] op_sel_hi:[1,0,1]
    v_lshlrev_b32 v186, 16, v233
    v_and_b32 v187, 0xffff0000, v233
    v_pk_mul_f32 v[82:83], v[82:83], v[36:37] op_sel_hi:[1,0]
    v_pk_fma_f32 v[82:83], v[186:187], v[4:5], v[82:83] op_sel_hi:[1,0,1]
    v_lshlrev_b32 v188, 16, v234
    v_and_b32 v189, 0xffff0000, v234
    v_pk_mul_f32 v[84:85], v[84:85], v[36:37] op_sel_hi:[1,0]
    v_pk_fma_f32 v[84:85], v[188:189], v[4:5], v[84:85] op_sel_hi:[1,0,1]
    v_lshlrev_b32 v190, 16, v235
    v_and_b32 v191, 0xffff0000, v235
    v_pk_mul_f32 v[86:87], v[86:87], v[36:37] op_sel_hi:[1,0]
    v_pk_fma_f32 v[86:87], v[190:191], v[4:5], v[86:87] op_sel_hi:[1,0,1]
    v_lshlrev_b32 v184, 16, v236
    v_and_b32 v185, 0xffff0000, v236
    v_pk_mul_f32 v[88:89], v[88:89], v[36:37] op_sel_hi:[1,0]
    v_pk_fma_f32 v[88:89], v[184:185], v[4:5], v[88:89] op_sel_hi:[1,0,1]
    v_lshlrev_b32 v186, 16, v237
    v_and_b32 v187, 0xffff0000, v237
    v_pk_mul_f32 v[90:91], v[90:91], v[36:37] op_sel_hi:[1,0]
    v_pk_fma_f32 v[90:91], v[186:187], v[4:5], v[90:91] op_sel_hi:[1,0,1]
    v_lshlrev_b32 v188, 16, v238
    v_and_b32 v189, 0xffff0000, v238
    v_pk_mul_f32 v[92:93], v[92:93], v[36:37] op_sel_hi:[1,0]
    v_pk_fma_f32 v[92:93], v[188:189], v[4:5], v[92:93] op_sel_hi:[1,0,1]
    v_lshlrev_b32 v190, 16, v239
    v_and_b32 v191, 0xffff0000, v239
    v_pk_mul_f32 v[94:95], v[94:95], v[36:37] op_sel_hi:[1,0]
    v_pk_fma_f32 v[94:95], v[190:191], v[4:5], v[94:95] op_sel_hi:[1,0,1]
    v_lshlrev_b32 v184, 16, v240
    v_and_b32 v185, 0xffff0000, v240
    v_pk_mul_f32 v[96:97], v[96:97], v[36:37] op_sel_hi:[1,0]
    v_pk_fma_f32 v[96:97], v[184:185], v[4:5], v[96:97] op_sel_hi:[1,0,1]
    v_lshlrev_b32 v186, 16, v241
    v_and_b32 v187, 0xffff0000, v241
    v_pk_mul_f32 v[98:99], v[98:99], v[36:37] op_sel_hi:[1,0]
    v_pk_fma_f32 v[98:99], v[186:187], v[4:5], v[98:99] op_sel_hi:[1,0,1]
    v_lshlrev_b32 v188, 16, v242
    v_and_b32 v189, 0xffff0000, v242
    v_pk_mul_f32 v[100:101], v[100:101], v[36:37] op_sel_hi:[1,0]
    v_pk_fma_f32 v[100:101], v[188:189], v[4:5], v[100:101] op_sel_hi:[1,0,1]
    v_lshlrev_b32 v190, 16, v243
    v_and_b32 v191, 0xffff0000, v243
    v_pk_mul_f32 v[102:103], v[102:103], v[36:37] op_sel_hi:[1,0]
    v_pk_fma_f32 v[102:103], v[190:191], v[4:5], v[102:103] op_sel_hi:[1,0,1]
L_mdone_80:
    s_cmp_lg_u32 s62, 0
    s_cbranch_scc1 L_issue_78
L_fin_77:
    s_lshl_b32 s53, s5, 4
    s_lshl_b32 s54, s4, 1
    s_add_u32 s53, s53, s54
    s_lshr_b32 s54, s3, 1
    s_add_u32 s53, s53, s54
    s_lshl_b32 s76, s53, 13
    v_mov_b32 v2, v35
    s_nop 1
    v_permlane16_swap_b32 v35, v2
    v_add_f32 v35, v35, v2
    v_mov_b32 v2, v35
    s_nop 1
    v_permlane32_swap_b32 v35, v2
    v_add_f32 v35, v35, v2
    v_rcp_f32 v36, v35
    s_nop 0
    v_pk_mul_f32 v[72:73], v[72:73], v[36:37] op_sel_hi:[1,0]
    v_pk_mul_f32 v[74:75], v[74:75], v[36:37] op_sel_hi:[1,0]
    v_pk_mul_f32 v[76:77], v[76:77], v[36:37] op_sel_hi:[1,0]
    v_pk_mul_f32 v[78:79], v[78:79], v[36:37] op_sel_hi:[1,0]
    v_cvt_pk_bf16_f32 v104, v72, v73
    v_cvt_pk_bf16_f32 v105, v74, v75
    v_cvt_pk_bf16_f32 v106, v76, v77
    v_cvt_pk_bf16_f32 v107, v78, v79
    s_nop 0
    v_permlane16_swap_b32 v104, v106
    v_permlane16_swap_b32 v105, v107
    buffer_store_dwordx4 v[104:107], v19, s[36:39], s76 offen offset:0
    v_pk_mul_f32 v[80:81], v[80:81], v[36:37] op_sel_hi:[1,0]
    v_pk_mul_f32 v[82:83], v[82:83], v[36:37] op_sel_hi:[1,0]
    v_pk_mul_f32 v[84:85], v[84:85], v[36:37] op_sel_hi:[1,0]
    v_pk_mul_f32 v[86:87], v[86:87], v[36:37] op_sel_hi:[1,0]
    v_cvt_pk_bf16_f32 v108, v80, v81
    v_cvt_pk_bf16_f32 v109, v82, v83
    v_cvt_pk_bf16_f32 v110, v84, v85
    v_cvt_pk_bf16_f32 v111, v86, v87
    s_nop 0
    v_permlane16_swap_b32 v108, v110
    v_permlane16_swap_b32 v109, v111
    buffer_store_dwordx4 v[108:111], v19, s[36:39], s76 offen offset:64
    v_pk_mul_f32 v[88:89], v[88:89], v[36:37] op_sel_hi:[1,0]
    v_pk_mul_f32 v[90:91], v[90:91], v[36:37] op_sel_hi:[1,0]
    v_pk_mul_f32 v[92:93], v[92:93], v[36:37] op_sel_hi:[1,0]
    v_pk_mul_f32 v[94:95], v[94:95], v[36:37] op_sel_hi:[1,0]
    v_cvt_pk_bf16_f32 v112, v88, v89
    v_cvt_pk_bf16_f32 v113, v90, v91
    v_cvt_pk_bf16_f32 v114, v92, v93
    v_cvt_pk_bf16_f32 v115, v94, v95
    s_nop 0
    v_permlane16_swap_b32 v112, v114
    v_permlane16_swap_b32 v113, v115
    buffer_store_dwordx4 v[112:115], v19, s[36:39], s76 offen offset:128
    v_pk_mul_f32 v[96:97], v[96:97], v[36:37] op_sel_hi:[1,0]
    v_pk_mul_f32 v[98:99], v[98:99], v[36:37] op_sel_hi:[1,0]
    v_pk_mul_f32 v[100:101], v[100:101], v[36:37] op_sel_hi:[1,0]
    v_pk_mul_f32 v[102:103], v[102:103], v[36:37] op_sel_hi:[1,0]
    v_cvt_pk_bf16_f32 v116, v96, v97
    v_cvt_pk_bf16_f32 v117, v98, v99
    v_cvt_pk_bf16_f32 v118, v100, v101
    v_cvt_pk_bf16_f32 v119, v102, v103
    s_nop 0
    v_permlane16_swap_b32 v116, v118
    v_permlane16_swap_b32 v117, v119
    buffer_store_dwordx4 v[116:119], v19, s[36:39], s76 offen offset:192
L_cend_72:
L_end:
    s_endpgm
.section .rodata,"a"
.p2align 6
.amdhsa_kernel standalone__paged_block_table_kv_pagedattention__sampling_kernel
.amdhsa_next_free_vgpr 250
.amdhsa_next_free_sgpr 84
.amdhsa_accum_offset 252
.amdhsa_group_segment_fixed_size 0
.amdhsa_kernarg_size 64
.amdhsa_user_sgpr_count 2
.amdhsa_user_sgpr_kernarg_segment_ptr 1
.amdhsa_system_sgpr_workgroup_id_x 1
.amdhsa_float_denorm_mode_32 3
.end_amdhsa_kernel
```
